```python
import torch

def _softmax(x, axis=-1):
    return torch.softmax(x, dim=axis)
def _gelu(x):
    return torch.nn.functional.gelu(x, approximate="tanh")
def _silu(x):
    return torch.nn.functional.silu(x)
def _sigmoid(x):
    return torch.sigmoid(x)
def _layernorm(x, axis=-1, eps=1e-5):
    m = x.mean(dim=axis, keepdim=True)
    v = x.var(dim=axis, keepdim=True, unbiased=False)
    return (x - m) / torch.sqrt(v + eps)
def _scatter_add(tgt, idx, src, axis=0):
    return tgt.clone().index_add_(axis, idx, src)
def _segment_sum(src, seg, n):
    out = torch.zeros((n,) + src.shape[1:], dtype=src.dtype)
    return out.index_add_(0, seg, src)
def _pad(x, pw):
    flat = tuple(v for pair in reversed(pw) for v in pair)
    return torch.nn.functional.pad(x, flat)

kernel_name = 'standalone__self_sup_conv_stem_wavlm__speech'

def setup_inputs():

    _w = (lambda a: (lambda t: t.to(torch.bfloat16) if t.is_floating_point() else t)(torch.as_tensor(a)))
    B, T, D, K = 2, 16000, 512, 3
    scale = (K * D) ** -0.5
    return {
        "x": _w((lambda *s: torch.randn(*s, dtype=torch.bfloat16) * 0.05)(B, T, D)),
        "w": _w((lambda *s: torch.randn(*s, dtype=torch.bfloat16) * 0.05)(K, D, D) * scale),
        "gn_gamma": _w((lambda *s: torch.randn(*s, dtype=torch.bfloat16) * 0.05)(D) * 0.1 + 1.0),
        "gn_beta": _w((lambda *s: torch.randn(*s, dtype=torch.bfloat16) * 0.05)(D) * 0.1),
    }

def reference(x, w, gn_gamma, gn_beta):
    B, T, D = x.shape
    K = w.shape[0]
    s = 2
    L = (T - K) // s + 1
    h = torch.einsum('blc,cd->bld', x[:, 0:s * L:s, :], w[0])
    for i in range(1, K):
        h = h + torch.einsum('blc,cd->bld', x[:, i:i + s * L:s, :], w[i])
    mu = torch.einsum('bld->bd', h)[:, None, :] / L
    var = torch.einsum('bld->bd', (h - mu) ** 2)[:, None, :] / L
    h = (h - mu) / torch.sqrt(var + 1e-5)
    h = h * gn_gamma[None, None, :] + gn_beta[None, None, :]
    return _gelu(h)
```

```asm
; @launch grid=(256,1,1) block=(512,1,1) lds=163840
.amdgcn_target "amdgcn-amd-amdhsa--gfx950"
.text
.globl standalone__self_sup_conv_stem_wavlm__speech_kernel
.p2align 8
.type standalone__self_sup_conv_stem_wavlm__speech_kernel,@function
standalone__self_sup_conv_stem_wavlm__speech_kernel:
    s_cmp_ge_u32 s2, 256
    s_cbranch_scc1 L_end
    s_load_dwordx4 s[4:7], s[0:1], 0
    s_load_dwordx4 s[28:31], s[0:1], 16
    s_load_dwordx4 s[32:35], s[0:1], 32
    s_load_dwordx2 s[36:37], s[0:1], 48
    v_lshrrev_b32 v1, 6, v0
    v_and_b32 v0, 63, v0
    v_readfirstlane_b32 s3, v1
    s_and_b32 s38, s2, 7
    s_bfe_u32 s40, s2, 0x30005
    s_bfe_u32 s41, s2, 0x20003
    s_lshl_b32 s42, s38, 3
    s_add_u32 s42, s42, s40
    s_lshr_b32 s43, s42, 5
    s_and_b32 s44, s42, 31
    s_mul_i32 s45, s44, 250
    s_mul_i32 s46, s43, 8000
    s_add_u32 s46, s46, s45
    s_cmp_eq_u32 s44, 31
    s_cselect_b32 s47, 1, 0
    s_sub_u32 s47, 250, s47
    s_lshl_b32 s48, s43, 2
    s_add_u32 s48, s48, s41
    s_and_b32 s49, s3, 3
    s_cmp_lt_u32 s3, 4
    s_cbranch_scc1 L_compute
    v_lshrrev_b32 v4, 4, v0
    v_and_b32 v5, 15, v0
    v_lshlrev_b32 v6, 1, v4
    v_xor_b32 v5, v5, v6
    s_and_b32 s50, s49, 1
    s_lshl_b32 s51, s50, 14
    s_lshl_b32 s52, s41, 8
    s_add_u32 s51, s51, s52
    v_lshlrev_b32 v5, 4, v5
    v_lshl_add_u32 v5, v4, 10, v5
    s_and_b32 s53, s40, 1
    s_mul_i32 s52, s53, 8320
    v_add_u32 v5, s51, v5
    v_xor_b32 v60, s52, v5
    v_xor_b32 v62, 8320, v60
    v_add_u32 v61, 3072, v60
    v_add_u32 v63, 3072, v62
    s_lshl_b32 s51, s49, 12
    s_lshl_b32 s53, s53, 11
    s_add_u32 s51, s51, s53
    s_add_u32 s51, s51, 98304
    s_lshr_b32 s62, s49, 1
    s_lshl_b32 s54, s62, 20
    s_mov_b32 s14, 1572864
    s_mov_b32 s15, 0x20000
    s_mov_b32 m0, s51
    s_waitcnt lgkmcnt(0)
    s_mov_b32 s12, s6
    s_mov_b32 s13, s7
    buffer_load_dwordx4 v60, s[12:15], s54 offen offset:0 lds
    buffer_load_dwordx4 v61, s[12:15], s54 offen offset:1024 lds
    v_and_b32 v5, 7, v0
    v_xor_b32 v5, v5, v4
    v_lshlrev_b32 v5, 4, v5
    v_lshrrev_b32 v6, 3, v0
    v_lshl_add_u32 v5, v6, 14, v5
    s_lshl_b32 s52, s62, 18
    s_lshl_b32 s53, s50, 13
    s_add_u32 s52, s52, s53
    s_and_b32 s53, s41, 1
    s_lshl_b32 s53, s53, 12
    s_add_u32 s52, s52, s53
    v_add_u32 v56, s52, v5
    v_xor_b32 v58, 4096, v56
    v_xor_b32 v57, 64, v56
    v_xor_b32 v59, 64, v58
    v_add_u32 v57, 130048, v57
    v_add_u32 v59, 130048, v59
    s_lshl_b32 s50, s49, 13
    s_add_u32 s50, s50, s53
    s_lshl_b32 s10, s47, 11
    s_add_u32 s10, s10, 1024
    s_mov_b32 s11, 0x20000
    s_lshl_b32 s57, s46, 11
    s_add_u32 s8, s4, s57
    s_addc_u32 s9, s5, 0
    s_mov_b32 s52, 0
    s_mov_b32 s53, 1024
    s_add_u32 s55, s54, 0x8000
    s_lshl_b32 s56, s62, 15
    s_add_u32 s56, s56, 0x80000
    s_add_u32 m0, s50, 0
    s_nop 0
    buffer_load_dwordx4 v56, s[8:11], s52 offen offset:0 lds
    buffer_load_dwordx4 v57, s[8:11], s52 offen offset:1024 lds
    buffer_load_dwordx4 v56, s[8:11], s52 offen offset:2048 lds
    buffer_load_dwordx4 v57, s[8:11], s52 offen offset:3072 lds
    s_add_u32 m0, s51, 16384
    s_nop 0
    buffer_load_dwordx4 v60, s[12:15], s55 offen offset:0 lds
    buffer_load_dwordx4 v61, s[12:15], s55 offen offset:1024 lds
    s_mov_b32 s20, s36
    s_mov_b32 s21, s37
    s_mov_b32 s22, 0x40000
    s_mov_b32 s23, 0x20000
    s_lshl_b32 s39, s48, 5
    s_add_u32 s39, s39, s44
    s_lshl_b32 s39, s39, 10
    v_lshlrev_b32 v86, 4, v0
    v_add_u32 v85, s39, v86
    v_and_b32 v1, 15, v0
    v_lshrrev_b32 v5, 5, v0
    v_lshl_add_u32 v5, v1, 1, v5
    s_lshl_b32 s57, s49, 5
    v_add_u32 v80, s57, v5
    s_lshl_b32 s57, s41, 7
    v_add_u32 v87, s57, v80
    v_lshlrev_b32 v87, 1, v87
    v_lshlrev_b32 v80, 2, v80
    v_lshlrev_b32 v1, 4, v1
    v_lshl_add_u32 v1, v4, 10, v1
    s_lshl_b32 s57, s48, 15
    s_lshl_b32 s58, s49, 8
    s_add_u32 s57, s57, s58
    v_add_u32 v83, s57, v1
    s_lshl_b32 s57, s48, 5
    v_mov_b32 v84, s57
    s_add_u32 s57, s39, s58
    v_lshl_add_u32 v88, v0, 2, s57
    v_mov_b32 v29, 0
    v_mov_b32 v90, 3212836864
    v_mov_b32 v91, 3212836864
    s_lshl_b32 s57, s49, 4
    s_lshl_b64 s[90:91], 0xffff, s57
    s_mov_b64 s[64:65], -1
    s_mov_b64 s[66:67], -1
    s_mov_b64 s[68:69], -1
    s_mov_b64 s[70:71], -1
    s_mov_b64 s[72:73], -1
    s_mov_b64 s[74:75], -1
    s_mov_b64 s[76:77], -1
    s_mov_b64 s[78:79], -1
    s_mov_b32 s81, 4096
    s_mov_b32 s82, 8192
    s_mov_b32 s83, 12288
    s_mov_b32 s84, 16384
    s_mov_b32 s85, 20480
    s_mov_b32 s86, 24576
    s_mov_b32 s87, 28672
    s_mul_i32 s38, s43, 7999
    s_add_u32 s38, s38, s45
    s_lshl_b32 s38, s38, 10
    s_add_u32 s16, s32, s38
    s_addc_u32 s17, s33, 0
    s_lshl_b32 s18, s47, 10
    s_mov_b32 s19, 0x20000
    v_and_b32 v1, 7, v0
    v_lshrrev_b32 v8, 3, v0
    s_and_b32 s38, s49, 1
    s_lshl_b32 s40, s38, 5
    s_add_u32 s40, s40, 0
    v_add_u32 v8, s40, v8
    s_lshl_b32 s38, s38, 2
    v_xor_b32 v9, s38, v1
    v_bfe_u32 v10, v0, 4, 1
    v_lshl_add_u32 v9, v10, 3, v9
    v_lshlrev_b32 v9, 4, v9
    v_lshl_add_u32 v9, v8, 8, v9
    s_lshr_b32 s38, s49, 1
    s_lshl_b32 s40, s38, 15
    s_add_u32 s42, s40, 98304
    v_add_u32 v6, s42, v9
    s_sub_u32 s40, s40, 98304
    s_lshl_b32 s42, s38, 7
    v_add_u32 v8, s42, v8
    v_lshlrev_b32 v8, 10, v8
    v_lshl_add_u32 v7, v1, 4, v8
    s_lshl_b32 s42, s41, 8
    v_add_u32 v7, s42, v7
    v_lshlrev_b32 v11, 5, v1
    v_and_b32 v14, 1, v0
    v_lshlrev_b32 v14, 2, v14
    v_and_b32 v12, 3, v0
    v_lshlrev_b32 v12, 2, v12
    v_mov_b32 v13, 1
    v_mov_b32 v8, v6
    v_xor_b32 v9, 160, v6
    v_mov_b32 v10, v7
    s_mov_b32 s24, 1084043516
    s_mov_b32 s25, 1084043516
    s_mov_b32 s26, 1055913304
    s_mov_b32 s27, 1055913304
    s_mov_b32 s42, 1
    s_add_u32 m0, s51, 0
    s_xor_b32 m0, m0, 2048
    s_nop 0
    buffer_load_dwordx4 v62, s[12:15], s54 offen offset:0 lds
    buffer_load_dwordx4 v63, s[12:15], s54 offen offset:1024 lds
    s_add_u32 m0, s50, 0
    s_xor_b32 m0, m0, 4096
    s_nop 0
    buffer_load_dwordx4 v58, s[8:11], s52 offen offset:0 lds
    buffer_load_dwordx4 v59, s[8:11], s52 offen offset:1024 lds
    buffer_load_dwordx4 v58, s[8:11], s52 offen offset:2048 lds
    buffer_load_dwordx4 v59, s[8:11], s52 offen offset:3072 lds
    s_add_u32 m0, s51, 16384
    s_xor_b32 m0, m0, 2048
    s_nop 0
    buffer_load_dwordx4 v62, s[12:15], s55 offen offset:0 lds
    buffer_load_dwordx4 v63, s[12:15], s55 offen offset:1024 lds
    s_waitcnt vmcnt(6)
    s_barrier
    buffer_store_dword v90, v88, s[20:23], 0 offen sc1
    global_load_ushort v81, v87, s[28:29]
    global_load_ushort v82, v87, s[30:31]
    s_lshl_b32 s57, s49, 9
    v_lshl_add_u32 v87, v0, 3, s57
    v_lshlrev_b32 v88, 2, v0
    v_mov_b32 v89, 0
    s_add_u32 m0, s51, 32768
    s_nop 0
    buffer_load_dwordx4 v60, s[12:15], s56 offen offset:0 lds
    buffer_load_dwordx4 v61, s[12:15], s56 offen offset:1024 lds
    s_xor_b32 m0, m0, 2048
    s_nop 0
    buffer_load_dwordx4 v62, s[12:15], s56 offen offset:0 lds
    buffer_load_dwordx4 v63, s[12:15], s56 offen offset:1024 lds
    s_mov_b32 s57, 65536
    s_mov_b32 s58, 32768
    s_mov_b32 s59, 49152
    s_waitcnt vmcnt(7)
    s_barrier
    s_add_u32 m0, s50, s58
    s_nop 0
    buffer_load_dwordx4 v56, s[8:11], s53 offen offset:0 lds
    buffer_load_dwordx4 v57, s[8:11], s53 offen offset:1024 lds
    buffer_load_dwordx4 v56, s[8:11], s53 offen offset:2048 lds
    buffer_load_dwordx4 v57, s[8:11], s53 offen offset:3072 lds
    s_add_u32 s54, s54, 0x10000
    s_add_u32 m0, s51, s59
    s_nop 0
    buffer_load_dwordx4 v60, s[12:15], s54 offen offset:0 lds
    buffer_load_dwordx4 v61, s[12:15], s54 offen offset:1024 lds
    s_add_u32 m0, s50, s58
    s_xor_b32 m0, m0, 4096
    s_nop 0
    buffer_load_dwordx4 v58, s[8:11], s53 offen offset:0 lds
    buffer_load_dwordx4 v59, s[8:11], s53 offen offset:1024 lds
    buffer_load_dwordx4 v58, s[8:11], s53 offen offset:2048 lds
    buffer_load_dwordx4 v59, s[8:11], s53 offen offset:3072 lds
    s_add_u32 m0, s51, s59
    s_xor_b32 m0, m0, 2048
    s_nop 0
    buffer_load_dwordx4 v62, s[12:15], s54 offen offset:0 lds
    buffer_load_dwordx4 v63, s[12:15], s54 offen offset:1024 lds
    s_add_u32 s59, s59, 16384
    s_and_b32 s59, s59, 0xffff
    s_waitcnt vmcnt(12)
    s_barrier
    s_add_u32 s52, s52, 128
    s_add_u32 m0, s50, s57
    s_nop 0
    buffer_load_dwordx4 v56, s[8:11], s52 offen offset:0 lds
    buffer_load_dwordx4 v57, s[8:11], s52 offen offset:1024 lds
    buffer_load_dwordx4 v56, s[8:11], s52 offen offset:2048 lds
    buffer_load_dwordx4 v57, s[8:11], s52 offen offset:3072 lds
    s_add_u32 s55, s55, 0x10000
    s_add_u32 m0, s51, s59
    s_nop 0
    buffer_load_dwordx4 v60, s[12:15], s55 offen offset:0 lds
    buffer_load_dwordx4 v61, s[12:15], s55 offen offset:1024 lds
    s_add_u32 m0, s50, s57
    s_xor_b32 m0, m0, 4096
    s_nop 0
    buffer_load_dwordx4 v58, s[8:11], s52 offen offset:0 lds
    buffer_load_dwordx4 v59, s[8:11], s52 offen offset:1024 lds
    buffer_load_dwordx4 v58, s[8:11], s52 offen offset:2048 lds
    buffer_load_dwordx4 v59, s[8:11], s52 offen offset:3072 lds
    s_add_u32 s61, s57, s58
    s_mov_b32 s57, s58
    s_sub_u32 s58, 98304, s61
    s_add_u32 m0, s51, s59
    s_xor_b32 m0, m0, 2048
    s_nop 0
    buffer_load_dwordx4 v62, s[12:15], s55 offen offset:0 lds
    buffer_load_dwordx4 v63, s[12:15], s55 offen offset:1024 lds
    s_add_u32 s59, s59, 16384
    s_and_b32 s59, s59, 0xffff
    s_waitcnt vmcnt(12)
    s_barrier
    s_add_u32 s56, s56, 0x10000
    s_add_u32 m0, s51, s59
    s_nop 0
    buffer_load_dwordx4 v60, s[12:15], s56 offen offset:0 lds
    buffer_load_dwordx4 v61, s[12:15], s56 offen offset:1024 lds
    s_add_u32 s53, s53, 128
    s_add_u32 m0, s50, s58
    s_nop 0
    buffer_load_dwordx4 v56, s[8:11], s53 offen offset:0 lds
    buffer_load_dwordx4 v57, s[8:11], s53 offen offset:1024 lds
    buffer_load_dwordx4 v56, s[8:11], s53 offen offset:2048 lds
    buffer_load_dwordx4 v57, s[8:11], s53 offen offset:3072 lds
    s_add_u32 m0, s51, s59
    s_xor_b32 m0, m0, 2048
    s_nop 0
    buffer_load_dwordx4 v62, s[12:15], s56 offen offset:0 lds
    buffer_load_dwordx4 v63, s[12:15], s56 offen offset:1024 lds
    s_add_u32 s59, s59, 16384
    s_and_b32 s59, s59, 0xffff
    s_add_u32 m0, s50, s58
    s_xor_b32 m0, m0, 4096
    s_nop 0
    buffer_load_dwordx4 v58, s[8:11], s53 offen offset:0 lds
    buffer_load_dwordx4 v59, s[8:11], s53 offen offset:1024 lds
    buffer_load_dwordx4 v58, s[8:11], s53 offen offset:2048 lds
    buffer_load_dwordx4 v59, s[8:11], s53 offen offset:3072 lds
    s_waitcnt vmcnt(12)
    s_barrier
    s_add_u32 s54, s54, 0x10000
    s_add_u32 m0, s51, s59
    s_nop 0
    buffer_load_dwordx4 v60, s[12:15], s54 offen offset:0 lds
    buffer_load_dwordx4 v61, s[12:15], s54 offen offset:1024 lds
    s_add_u32 s52, s52, 128
    s_add_u32 m0, s50, s57
    s_nop 0
    buffer_load_dwordx4 v56, s[8:11], s52 offen offset:0 lds
    buffer_load_dwordx4 v57, s[8:11], s52 offen offset:1024 lds
    buffer_load_dwordx4 v56, s[8:11], s52 offen offset:2048 lds
    buffer_load_dwordx4 v57, s[8:11], s52 offen offset:3072 lds
    s_add_u32 m0, s51, s59
    s_xor_b32 m0, m0, 2048
    s_nop 0
    buffer_load_dwordx4 v62, s[12:15], s54 offen offset:0 lds
    buffer_load_dwordx4 v63, s[12:15], s54 offen offset:1024 lds
    s_add_u32 s59, s59, 16384
    s_and_b32 s59, s59, 0xffff
    s_add_u32 m0, s50, s57
    s_xor_b32 m0, m0, 4096
    s_nop 0
    buffer_load_dwordx4 v58, s[8:11], s52 offen offset:0 lds
    buffer_load_dwordx4 v59, s[8:11], s52 offen offset:1024 lds
    buffer_load_dwordx4 v58, s[8:11], s52 offen offset:2048 lds
    buffer_load_dwordx4 v59, s[8:11], s52 offen offset:3072 lds
    s_add_u32 s61, s57, s58
    s_mov_b32 s57, s58
    s_sub_u32 s58, 98304, s61
    s_waitcnt vmcnt(16)
    s_barrier
    s_add_u32 s55, s55, 0x10000
    s_add_u32 m0, s51, s59
    s_nop 0
    buffer_load_dwordx4 v60, s[12:15], s55 offen offset:0 lds
    buffer_load_dwordx4 v61, s[12:15], s55 offen offset:1024 lds
    s_xor_b32 m0, m0, 2048
    s_nop 0
    buffer_load_dwordx4 v62, s[12:15], s55 offen offset:0 lds
    buffer_load_dwordx4 v63, s[12:15], s55 offen offset:1024 lds
    s_add_u32 s59, s59, 16384
    s_and_b32 s59, s59, 0xffff
    s_add_u32 s56, s56, 0x10000
    s_add_u32 m0, s51, s59
    s_nop 0
    buffer_load_dwordx4 v60, s[12:15], s56 offen offset:0 lds
    buffer_load_dwordx4 v61, s[12:15], s56 offen offset:1024 lds
    s_waitcnt vmcnt(10)
    s_barrier
    s_add_u32 m0, s51, s59
    s_xor_b32 m0, m0, 2048
    s_nop 0
    buffer_load_dwordx4 v62, s[12:15], s56 offen offset:0 lds
    buffer_load_dwordx4 v63, s[12:15], s56 offen offset:1024 lds
    s_add_u32 s59, s59, 16384
    s_and_b32 s59, s59, 0xffff
    s_add_u32 s54, s54, 0x10000
    s_add_u32 m0, s51, s59
    s_nop 0
    buffer_load_dwordx4 v60, s[12:15], s54 offen offset:0 lds
    buffer_load_dwordx4 v61, s[12:15], s54 offen offset:1024 lds
    s_add_u32 s53, s53, 128
    s_add_u32 m0, s50, s58
    s_nop 0
    buffer_load_dwordx4 v56, s[8:11], s53 offen offset:0 lds
    buffer_load_dwordx4 v57, s[8:11], s53 offen offset:1024 lds
    buffer_load_dwordx4 v56, s[8:11], s53 offen offset:2048 lds
    buffer_load_dwordx4 v57, s[8:11], s53 offen offset:3072 lds
    s_waitcnt vmcnt(10)
    s_barrier
    s_mov_b32 s60, 4
    s_and_b32 s62, s44, 3
    s_min_u32 s62, s62, 2
    s_add_u32 s62, s62, 2
    s_cmp_lg_u32 s49, 0
    s_cselect_b32 s62, 0, s62
L_lloop:
    s_add_u32 m0, s51, s59
    s_xor_b32 m0, m0, 2048
    s_nop 0
    buffer_load_dwordx4 v62, s[12:15], s54 offen offset:0 lds
    buffer_load_dwordx4 v63, s[12:15], s54 offen offset:1024 lds
    s_add_u32 s59, s59, 16384
    s_and_b32 s59, s59, 0xffff
    s_add_u32 m0, s50, s58
    s_xor_b32 m0, m0, 4096
    s_nop 0
    buffer_load_dwordx4 v58, s[8:11], s53 offen offset:0 lds
    buffer_load_dwordx4 v59, s[8:11], s53 offen offset:1024 lds
    buffer_load_dwordx4 v58, s[8:11], s53 offen offset:2048 lds
    buffer_load_dwordx4 v59, s[8:11], s53 offen offset:3072 lds
    s_add_u32 s55, s55, 0x10000
    s_add_u32 m0, s51, s59
    s_nop 0
    buffer_load_dwordx4 v60, s[12:15], s55 offen offset:0 lds
    buffer_load_dwordx4 v61, s[12:15], s55 offen offset:1024 lds
    s_add_u32 s52, s52, 128
    s_add_u32 m0, s50, s57
    s_nop 0
    buffer_load_dwordx4 v56, s[8:11], s52 offen offset:0 lds
    buffer_load_dwordx4 v57, s[8:11], s52 offen offset:1024 lds
    buffer_load_dwordx4 v56, s[8:11], s52 offen offset:2048 lds
    buffer_load_dwordx4 v57, s[8:11], s52 offen offset:3072 lds
    s_waitcnt vmcnt(18)
    s_barrier
    s_add_u32 m0, s51, s59
    s_xor_b32 m0, m0, 2048
    s_nop 0
    buffer_load_dwordx4 v62, s[12:15], s55 offen offset:0 lds
    buffer_load_dwordx4 v63, s[12:15], s55 offen offset:1024 lds
    s_add_u32 s59, s59, 16384
    s_and_b32 s59, s59, 0xffff
    s_add_u32 m0, s50, s57
    s_xor_b32 m0, m0, 4096
    s_nop 0
    buffer_load_dwordx4 v58, s[8:11], s52 offen offset:0 lds
    buffer_load_dwordx4 v59, s[8:11], s52 offen offset:1024 lds
    buffer_load_dwordx4 v58, s[8:11], s52 offen offset:2048 lds
    buffer_load_dwordx4 v59, s[8:11], s52 offen offset:3072 lds
    s_add_u32 s61, s57, s58
    s_mov_b32 s57, s58
    s_sub_u32 s58, 98304, s61
    s_add_u32 s56, s56, 0x10000
    s_add_u32 m0, s51, s59
    s_nop 0
    buffer_load_dwordx4 v60, s[12:15], s56 offen offset:0 lds
    buffer_load_dwordx4 v61, s[12:15], s56 offen offset:1024 lds
    s_waitcnt vmcnt(14)
    s_cmp_lg_u32 s60, s62
    s_cbranch_scc1 L_noat
    s_mov_b64 exec, 1
    global_atomic_add v84, v13, s[34:35]
    s_mov_b64 exec, -1
L_noat:
    s_barrier
    s_add_u32 m0, s51, s59
    s_xor_b32 m0, m0, 2048
    s_nop 0
    buffer_load_dwordx4 v62, s[12:15], s56 offen offset:0 lds
    buffer_load_dwordx4 v63, s[12:15], s56 offen offset:1024 lds
    s_add_u32 s59, s59, 16384
    s_and_b32 s59, s59, 0xffff
    s_add_u32 s54, s54, 0x10000
    s_add_u32 m0, s51, s59
    s_nop 0
    buffer_load_dwordx4 v60, s[12:15], s54 offen offset:0 lds
    buffer_load_dwordx4 v61, s[12:15], s54 offen offset:1024 lds
    s_add_u32 s53, s53, 128
    s_add_u32 m0, s50, s58
    s_nop 0
    buffer_load_dwordx4 v56, s[8:11], s53 offen offset:0 lds
    buffer_load_dwordx4 v57, s[8:11], s53 offen offset:1024 lds
    buffer_load_dwordx4 v56, s[8:11], s53 offen offset:2048 lds
    buffer_load_dwordx4 v57, s[8:11], s53 offen offset:3072 lds
    s_waitcnt vmcnt(10)
    s_barrier
    s_sub_u32 s60, s60, 1
    s_cmp_lg_u32 s60, 0
    s_cbranch_scc1 L_lloop
    s_add_u32 m0, s51, s59
    s_xor_b32 m0, m0, 2048
    s_nop 0
    buffer_load_dwordx4 v62, s[12:15], s54 offen offset:0 lds
    buffer_load_dwordx4 v63, s[12:15], s54 offen offset:1024 lds
    s_add_u32 s59, s59, 16384
    s_and_b32 s59, s59, 0xffff
    s_add_u32 m0, s50, s58
    s_xor_b32 m0, m0, 4096
    s_nop 0
    buffer_load_dwordx4 v58, s[8:11], s53 offen offset:0 lds
    buffer_load_dwordx4 v59, s[8:11], s53 offen offset:1024 lds
    buffer_load_dwordx4 v58, s[8:11], s53 offen offset:2048 lds
    buffer_load_dwordx4 v59, s[8:11], s53 offen offset:3072 lds
    s_add_u32 s55, s55, 0x10000
    s_add_u32 m0, s51, s59
    s_nop 0
    buffer_load_dwordx4 v60, s[12:15], s55 offen offset:0 lds
    buffer_load_dwordx4 v61, s[12:15], s55 offen offset:1024 lds
    s_add_u32 s52, s52, 128
    s_add_u32 m0, s50, s57
    s_nop 0
    buffer_load_dwordx4 v56, s[8:11], s52 offen offset:0 lds
    buffer_load_dwordx4 v57, s[8:11], s52 offen offset:1024 lds
    buffer_load_dwordx4 v56, s[8:11], s52 offen offset:2048 lds
    buffer_load_dwordx4 v57, s[8:11], s52 offen offset:3072 lds
    s_waitcnt vmcnt(18)
    s_barrier
    s_add_u32 m0, s51, s59
    s_xor_b32 m0, m0, 2048
    s_nop 0
    buffer_load_dwordx4 v62, s[12:15], s55 offen offset:0 lds
    buffer_load_dwordx4 v63, s[12:15], s55 offen offset:1024 lds
    s_add_u32 s59, s59, 16384
    s_and_b32 s59, s59, 0xffff
    s_add_u32 m0, s50, s57
    s_xor_b32 m0, m0, 4096
    s_nop 0
    buffer_load_dwordx4 v58, s[8:11], s52 offen offset:0 lds
    buffer_load_dwordx4 v59, s[8:11], s52 offen offset:1024 lds
    buffer_load_dwordx4 v58, s[8:11], s52 offen offset:2048 lds
    buffer_load_dwordx4 v59, s[8:11], s52 offen offset:3072 lds
    s_add_u32 s61, s57, s58
    s_mov_b32 s57, s58
    s_sub_u32 s58, 98304, s61
    s_add_u32 s56, s56, 0x10000
    s_add_u32 m0, s51, s59
    s_nop 0
    buffer_load_dwordx4 v60, s[12:15], s56 offen offset:0 lds
    buffer_load_dwordx4 v61, s[12:15], s56 offen offset:1024 lds
    s_waitcnt vmcnt(14)
    s_barrier
    s_add_u32 m0, s51, s59
    s_xor_b32 m0, m0, 2048
    s_nop 0
    buffer_load_dwordx4 v62, s[12:15], s56 offen offset:0 lds
    buffer_load_dwordx4 v63, s[12:15], s56 offen offset:1024 lds
    s_add_u32 s59, s59, 16384
    s_and_b32 s59, s59, 0xffff
    s_add_u32 s53, s53, 128
    s_add_u32 m0, s50, s58
    s_nop 0
    buffer_load_dwordx4 v56, s[8:11], s53 offen offset:0 lds
    buffer_load_dwordx4 v57, s[8:11], s53 offen offset:1024 lds
    buffer_load_dwordx4 v56, s[8:11], s53 offen offset:2048 lds
    buffer_load_dwordx4 v57, s[8:11], s53 offen offset:3072 lds
    s_xor_b32 m0, m0, 4096
    s_nop 0
    buffer_load_dwordx4 v58, s[8:11], s53 offen offset:0 lds
    buffer_load_dwordx4 v59, s[8:11], s53 offen offset:1024 lds
    buffer_load_dwordx4 v58, s[8:11], s53 offen offset:2048 lds
    buffer_load_dwordx4 v59, s[8:11], s53 offen offset:3072 lds
    s_waitcnt vmcnt(12)
    s_barrier
    s_branch L_ltail
.p2align 12
L_page:
L_compute:
    s_getpc_b64 s[52:53]
L_pfbase:
    s_sub_u32 s52, s52, L_pfbase-L_compute
    s_subb_u32 s53, s53, 0
    s_lshl_b32 s50, s49, 5
    s_add_u32 s50, s50, s40
    s_lshl_b32 s50, s50, 7
    v_lshl_add_u32 v1, v0, 10, s50
    v_min_u32 v1, L_end-L_compute, v1
    s_mov_b64 exec, 15
    global_load_dword v30, v1, s[52:53]
    s_mov_b64 exec, -1
    s_lshr_b32 s50, s49, 1
    s_and_b32 s51, s49, 1
    v_and_b32 v32, 15, v0
    v_lshrrev_b32 v33, 4, v0
    s_lshl_b32 s52, s50, 14
    v_bfe_u32 v34, v32, 1, 3
    v_xor_b32 v34, v34, v33
    v_lshlrev_b32 v34, 4, v34
    v_lshl_add_u32 v34, v32, 7, v34
    v_add_u32 v16, s52, v34
    v_xor_b32 v17, 64, v16
    v_add_u32 v20, 32768, v16
    v_add_u32 v21, 32768, v17
    v_add_u32 v35, 1, v32
    s_mul_i32 s52, s50, 127
    s_add_u32 s52, s52, 128
    s_lshl_b32 s53, s50, 7
    v_add_u32 v35, s53, v35
    v_mov_b32 v36, s52
    v_cmp_eq_u32 vcc, 15, v32
    s_nop 1
    v_cndmask_b32 v35, v35, v36, vcc
    v_bfe_u32 v34, v35, 1, 3
    v_xor_b32 v34, v34, v33
    v_lshlrev_b32 v34, 4, v34
    v_lshl_add_u32 v18, v35, 7, v34
    v_xor_b32 v19, 64, v18
    v_bfe_u32 v34, v0, 2, 2
    v_lshl_add_u32 v35, v33, 3, v34
    v_bfe_u32 v34, v0, 2, 3
    v_lshlrev_b32 v34, 5, v34
    s_lshl_b32 s52, s51, 6
    v_xor_b32 v34, s52, v34
    v_and_b32 v36, 3, v0
    v_lshl_add_u32 v34, v36, 3, v34
    v_lshl_add_u32 v34, v35, 8, v34
    v_add_u32 v22, 98304, v34
    v_xor_b32 v23, 32, v22
    v_xor_b32 v24, 128, v22
    v_xor_b32 v25, 160, v22
    s_mov_b64 s[64:65], -1
    s_mov_b64 s[66:67], -1
    s_cmp_eq_u32 s50, 0
    s_cbranch_scc1 L_nomask
    s_cmp_eq_u32 s47, 249
    s_cselect_b32 s65, 0xffff, -1
    s_cselect_b32 s67, -1, 0xffff
L_nomask:
    v_bfe_u32 v34, v32, 2, 1
    v_mul_u32_u24 v34, 10, v34
    v_lshrrev_b32 v35, 3, v32
    v_or_b32 v34, v34, v35
    v_and_b32 v35, 1, v33
    v_xor_b32 v35, s51, v35
    v_lshl_add_u32 v34, v35, 2, v34
    v_lshlrev_b32 v34, 4, v34
    v_and_b32 v35, 3, v32
    v_lshl_add_u32 v34, v35, 2, v34
    v_lshl_add_u32 v34, v33, 13, v34
    s_lshl_b32 s52, s50, 15
    s_add_u32 s52, s52, 98304
    v_add_u32 v26, s52, v34
    v_lshrrev_b32 v34, 5, v0
    v_lshl_add_u32 v34, v34, 4, v32
    s_lshl_b32 s52, s49, 8
    v_lshl_add_u32 v27, v34, 3, s52
    v_lshlrev_b32 v28, 4, v0
    s_lshl_b32 s39, s48, 5
    s_add_u32 s39, s39, s44
    s_lshl_b32 s39, s39, 10
    s_add_u32 s39, s39, 512
    v_add_u32 v29, s39, v28
    s_lshl_b32 s52, s49, 3
    s_lshl_b64 s[90:91], 0xff, s52
    s_lshl_b32 s52, s49, 2
    v_mov_b32 v15, s52
    s_waitcnt lgkmcnt(0)
    s_mov_b32 s20, s36
    s_mov_b32 s21, s37
    s_mov_b32 s22, 0x40000
    s_mov_b32 s23, 0x20000
    s_mul_i32 s38, s43, 7999
    s_add_u32 s38, s38, s45
    s_lshl_b32 s38, s38, 10
    s_add_u32 s16, s32, s38
    s_addc_u32 s17, s33, 0
    s_lshl_b32 s18, s47, 10
    s_mov_b32 s19, 0x20000
    v_and_b32 v1, 7, v0
    v_lshrrev_b32 v8, 3, v0
    s_and_b32 s38, s49, 1
    s_lshl_b32 s40, s38, 5
    s_add_u32 s40, s40, 64
    v_add_u32 v8, s40, v8
    s_lshl_b32 s38, s38, 2
    v_xor_b32 v9, s38, v1
    v_bfe_u32 v10, v0, 4, 1
    v_lshl_add_u32 v9, v10, 3, v9
    v_lshlrev_b32 v9, 4, v9
    v_lshl_add_u32 v9, v8, 8, v9
    s_lshr_b32 s38, s49, 1
    s_lshl_b32 s40, s38, 15
    s_add_u32 s42, s40, 98304
    v_add_u32 v6, s42, v9
    s_sub_u32 s40, s40, 98304
    s_lshl_b32 s42, s38, 7
    v_add_u32 v8, s42, v8
    v_lshlrev_b32 v8, 10, v8
    v_lshl_add_u32 v7, v1, 4, v8
    s_lshl_b32 s42, s41, 8
    v_add_u32 v7, s42, v7
    v_lshlrev_b32 v11, 5, v1
    v_and_b32 v14, 1, v0
    v_lshlrev_b32 v14, 2, v14
    v_and_b32 v12, 3, v0
    v_lshlrev_b32 v12, 2, v12
    v_mov_b32 v13, 1
    v_mov_b32 v8, v6
    v_xor_b32 v9, 160, v6
    v_mov_b32 v10, v7
    s_mov_b32 s24, 1084043516
    s_mov_b32 s25, 1084043516
    s_mov_b32 s26, 1055913304
    s_mov_b32 s27, 1055913304
    s_mov_b32 s42, 1
    v_mov_b64 v[128:129], 0
    v_mov_b64 v[130:131], 0
    v_mov_b64 v[132:133], 0
    v_mov_b64 v[134:135], 0
    v_mov_b64 v[136:137], 0
    v_mov_b64 v[138:139], 0
    v_mov_b64 v[140:141], 0
    v_mov_b64 v[142:143], 0
    v_mov_b64 v[144:145], 0
    v_mov_b64 v[146:147], 0
    v_mov_b64 v[148:149], 0
    v_mov_b64 v[150:151], 0
    v_mov_b64 v[152:153], 0
    v_mov_b64 v[154:155], 0
    v_mov_b64 v[156:157], 0
    v_mov_b64 v[158:159], 0
    v_mov_b64 v[160:161], 0
    v_mov_b64 v[162:163], 0
    v_mov_b64 v[164:165], 0
    v_mov_b64 v[166:167], 0
    v_mov_b64 v[168:169], 0
    v_mov_b64 v[170:171], 0
    v_mov_b64 v[172:173], 0
    v_mov_b64 v[174:175], 0
    v_mov_b64 v[176:177], 0
    v_mov_b64 v[178:179], 0
    v_mov_b64 v[180:181], 0
    v_mov_b64 v[182:183], 0
    v_mov_b64 v[184:185], 0
    v_mov_b64 v[186:187], 0
    v_mov_b64 v[188:189], 0
    v_mov_b64 v[190:191], 0
    v_mov_b64 v[192:193], 0
    v_mov_b64 v[194:195], 0
    v_mov_b64 v[196:197], 0
    v_mov_b64 v[198:199], 0
    v_mov_b64 v[200:201], 0
    v_mov_b64 v[202:203], 0
    v_mov_b64 v[204:205], 0
    v_mov_b64 v[206:207], 0
    v_mov_b64 v[208:209], 0
    v_mov_b64 v[210:211], 0
    v_mov_b64 v[212:213], 0
    v_mov_b64 v[214:215], 0
    v_mov_b64 v[216:217], 0
    v_mov_b64 v[218:219], 0
    v_mov_b64 v[220:221], 0
    v_mov_b64 v[222:223], 0
    v_mov_b64 v[224:225], 0
    v_mov_b64 v[226:227], 0
    v_mov_b64 v[228:229], 0
    v_mov_b64 v[230:231], 0
    v_mov_b64 v[232:233], 0
    v_mov_b64 v[234:235], 0
    v_mov_b64 v[236:237], 0
    v_mov_b64 v[238:239], 0
    v_mov_b64 v[240:241], 0
    v_mov_b64 v[242:243], 0
    v_mov_b64 v[244:245], 0
    v_mov_b64 v[246:247], 0
    v_mov_b64 v[248:249], 0
    v_mov_b64 v[250:251], 0
    v_mov_b64 v[252:253], 0
    v_mov_b64 v[254:255], 0
    s_mov_b32 s54, 0
    s_mov_b32 s55, 32768
    s_mov_b32 s56, 0
    s_mov_b32 s57, 4
    s_mov_b32 s63, 16384
    s_mov_b32 s61, 16
    s_barrier
    ds_read_b64_tr_b16 v[64:65], v22 offset:0
    ds_read_b64_tr_b16 v[66:67], v22 offset:1024
    ds_read_b64_tr_b16 v[80:81], v22 offset:8192
    ds_read_b64_tr_b16 v[82:83], v22 offset:9216
    ds_read_b64_tr_b16 v[68:69], v23 offset:0
    ds_read_b64_tr_b16 v[70:71], v23 offset:1024
    ds_read_b64_tr_b16 v[84:85], v23 offset:8192
    ds_read_b64_tr_b16 v[86:87], v23 offset:9216
    ds_read_b64_tr_b16 v[72:73], v24 offset:0
    ds_read_b64_tr_b16 v[74:75], v24 offset:1024
    ds_read_b64_tr_b16 v[88:89], v24 offset:8192
    ds_read_b64_tr_b16 v[90:91], v24 offset:9216
    ds_read_b64_tr_b16 v[76:77], v25 offset:0
    ds_read_b64_tr_b16 v[78:79], v25 offset:1024
    ds_read_b64_tr_b16 v[92:93], v25 offset:8192
    ds_read_b64_tr_b16 v[94:95], v25 offset:9216
    s_add_u32 s56, s56, 16384
    s_cmp_eq_u32 s56, 0x10000
    s_cselect_b32 s58, 0xffff4000, s63
    s_and_b32 s56, s56, 0xffff
    v_add_u32 v22, s58, v22
    v_add_u32 v23, s58, v23
    v_add_u32 v24, s58, v24
    v_add_u32 v25, s58, v25
    s_waitcnt lgkmcnt(0)
    s_barrier
    ds_read_b128 v[32:35], v16 offset:0
    ds_read_b128 v[36:39], v16 offset:2048
    ds_read_b128 v[40:43], v16 offset:4096
    s_branch L_cloop
L_ltail:
    ds_write_b64 v87, v[90:91] offset:32768
    ds_write_b32 v88, v89 offset:35840
    s_waitcnt lgkmcnt(0)
    s_waitcnt vmcnt(8)
    s_barrier
    s_waitcnt vmcnt(0)
    s_barrier
    global_load_dword v89, v84, s[34:35] sc1
    s_mov_b32 s52, 1055913304
    v_lshlrev_b32 v81, 16, v81
    v_lshlrev_b32 v82, 16, v82
    v_mul_f32 v81, s52, v81
    v_mul_f32 v82, s52, v82
    s_mov_b32 s59, 262144
    s_barrier
    s_setprio 2
    s_cmp_ge_u32 s49, 2
    s_cbranch_scc1 L_nopub
L_part:
    ds_read_b128 v[96:99], v86 offset:32768
    s_waitcnt lgkmcnt(0)
    v_min_f32 v1, v97, v99
    v_cmp_gt_f32 vcc, 0, v1
    s_cbranch_vccz L_part_ok
    s_sleep 1
    s_sub_u32 s59, s59, 1
    s_cmp_gt_i32 s59, 0
    s_cbranch_scc1 L_part
L_part_ok:
    v_mov_b32 v100, v96
    v_mov_b32 v101, v97
    v_mov_b32 v102, v98
    v_mov_b32 v103, v99
    v_permlane32_swap_b32 v96, v100
    v_permlane32_swap_b32 v97, v101
    v_permlane32_swap_b32 v98, v102
    v_permlane32_swap_b32 v99, v103
    v_add_f32 v96, v96, v100
    v_add_f32 v97, v97, v101
    v_add_f32 v98, v98, v102
    v_add_f32 v99, v99, v103
    s_mov_b64 exec, s[90:91]
    buffer_store_dwordx4 v[96:99], v85, s[20:23], 0 offen sc1
    s_mov_b64 exec, -1
L_nopub:
L_cnt:
    s_waitcnt vmcnt(0)
L_cnt1:
    v_readfirstlane_b32 s52, v89
    s_cmp_ge_u32 s52, 32
    s_cbranch_scc1 L_cnt_ok
    s_sleep 32
    global_load_dword v89, v84, s[34:35] sc1
    s_sub_u32 s59, s59, 1
    s_cmp_gt_i32 s59, 0
    s_cbranch_scc1 L_cnt
L_cnt_ok:
    s_cmp_lt_u32 s49, 2
    s_cbranch_scc1 L_gather
    s_branch L_imgwait
L_gather:
    s_mov_b32 s59, 262144
L_poll:
    s_or_b64 exec, s[64:65], 1
    buffer_load_dwordx4 v[96:99], v83, s[20:23], 0 offen sc1
    s_or_b64 exec, s[66:67], 1
    buffer_load_dwordx4 v[100:103], v83, s[20:23], s81 offen sc1
    s_or_b64 exec, s[68:69], 1
    buffer_load_dwordx4 v[104:107], v83, s[20:23], s82 offen sc1
    s_or_b64 exec, s[70:71], 1
    buffer_load_dwordx4 v[108:111], v83, s[20:23], s83 offen sc1
    s_or_b64 exec, s[72:73], 1
    buffer_load_dwordx4 v[112:115], v83, s[20:23], s84 offen sc1
    s_or_b64 exec, s[74:75], 1
    buffer_load_dwordx4 v[116:119], v83, s[20:23], s85 offen sc1
    s_or_b64 exec, s[76:77], 1
    buffer_load_dwordx4 v[120:123], v83, s[20:23], s86 offen sc1
    s_or_b64 exec, s[78:79], 1
    buffer_load_dwordx4 v[124:127], v83, s[20:23], s87 offen sc1
    s_mov_b64 exec, -1
    s_waitcnt vmcnt(0)
    v_min_f32 v1, v97, v99
    v_cmp_gt_f32 s[64:65], 0, v1
    v_min_f32 v1, v101, v103
    v_cmp_gt_f32 s[66:67], 0, v1
    v_min_f32 v1, v105, v107
    v_cmp_gt_f32 s[68:69], 0, v1
    v_min_f32 v1, v109, v111
    v_cmp_gt_f32 s[70:71], 0, v1
    v_min_f32 v1, v113, v115
    v_cmp_gt_f32 s[72:73], 0, v1
    v_min_f32 v1, v117, v119
    v_cmp_gt_f32 s[74:75], 0, v1
    v_min_f32 v1, v121, v123
    v_cmp_gt_f32 s[76:77], 0, v1
    v_min_f32 v1, v125, v127
    v_cmp_gt_f32 s[78:79], 0, v1
    s_or_b64 s[52:53], s[64:65], s[66:67]
    s_or_b64 s[52:53], s[52:53], s[68:69]
    s_or_b64 s[52:53], s[52:53], s[70:71]
    s_or_b64 s[52:53], s[52:53], s[72:73]
    s_or_b64 s[52:53], s[52:53], s[74:75]
    s_or_b64 s[52:53], s[52:53], s[76:77]
    s_or_b64 s[52:53], s[52:53], s[78:79]
    s_cbranch_scc0 L_poll_done
    s_sub_u32 s59, s59, 1
    s_cmp_gt_i32 s59, 0
    s_cbranch_scc1 L_poll
L_poll_done:
    v_add_f32 v96, v96, v112
    v_add_f32 v97, v97, v113
    v_add_f32 v98, v98, v114
    v_add_f32 v99, v99, v115
    v_add_f32 v100, v100, v116
    v_add_f32 v101, v101, v117
    v_add_f32 v102, v102, v118
    v_add_f32 v103, v103, v119
    v_add_f32 v104, v104, v120
    v_add_f32 v105, v105, v121
    v_add_f32 v106, v106, v122
    v_add_f32 v107, v107, v123
    v_add_f32 v108, v108, v124
    v_add_f32 v109, v109, v125
    v_add_f32 v110, v110, v126
    v_add_f32 v111, v111, v127
    v_add_f32 v96, v96, v104
    v_add_f32 v97, v97, v105
    v_add_f32 v98, v98, v106
    v_add_f32 v99, v99, v107
    v_add_f32 v100, v100, v108
    v_add_f32 v101, v101, v109
    v_add_f32 v102, v102, v110
    v_add_f32 v103, v103, v111
    v_add_f32 v96, v96, v100
    v_add_f32 v97, v97, v101
    v_add_f32 v98, v98, v102
    v_add_f32 v99, v99, v103
    s_mov_b32 s52, 956503712
    s_nop 0
    v_permlane32_swap_b32 v96, v98
    v_permlane32_swap_b32 v97, v99
    s_nop 1
    v_add_f32 v96, v96, v98
    v_add_f32 v97, v97, v99
    v_mov_b32 v98, v96
    v_mov_b32 v99, v97
    s_nop 1
    v_permlane16_swap_b32 v96, v98
    v_permlane16_swap_b32 v97, v99
    s_nop 1
    v_add_f32 v96, v96, v98
    v_add_f32 v97, v97, v99
    v_mul_f32 v96, s52, v96
    v_mul_f32 v97, s52, v97
    v_fma_f32 v97, -v96, v96, v97
    v_max_f32 v97, 0, v97
    v_add_f32 v97, 925353388, v97
    v_rsq_f32 v97, v97
    s_lshl_b32 s52, s49, 2
    v_mul_f32 v97, v97, v81
    v_mov_b32 v1, s52
    v_fma_f32 v96, -v96, v97, v82
    ds_write_b32 v80, v97 offset:34816
    ds_write_b32 v80, v96 offset:35328
    ds_write_b32 v1, v13 offset:35840
    s_mov_b32 s59, 4194304
    s_branch L_imgwait
L_imgwait:
    s_mov_b32 s59, 4194304
L_img:
    ds_read_b32 v15, v12 offset:35856
    s_waitcnt lgkmcnt(0)
    v_cmp_eq_u32 vcc, 0, v15
    s_cbranch_vccz L_job
    s_sleep 2
    s_sub_u32 s59, s59, 1
    s_cmp_gt_i32 s59, 0
    s_cbranch_scc1 L_img
L_job:
    ds_read_b128 v[184:187], v8 offset:6144
    ds_read_b128 v[188:191], v9 offset:6144
    ds_read_b128 v[176:179], v8 offset:4096
    ds_read_b128 v[180:183], v9 offset:4096
    ds_read_b128 v[168:171], v8 offset:2048
    ds_read_b128 v[172:175], v9 offset:2048
    ds_read_b128 v[160:163], v8 offset:0
    ds_read_b128 v[164:167], v9 offset:0
    v_add_u32 v61, 8192, v10
    v_add_u32 v62, 16384, v10
    v_add_u32 v63, 24576, v10
L_fw:
    ds_read_b32 v15, v14 offset:35840
    ds_read_b128 v[16:19], v11 offset:34816
    ds_read_b128 v[20:23], v11 offset:34832
    ds_read_b128 v[24:27], v11 offset:35328
    ds_read_b128 v[28:31], v11 offset:35344
    s_waitcnt lgkmcnt(0)
    v_cmp_eq_u32 vcc, 0, v15
    s_cbranch_vccz L_fw_ok
    s_sleep 1
    s_sub_u32 s59, s59, 1
    s_cmp_gt_i32 s59, 0
    s_cbranch_scc1 L_fw
L_fw_ok:
    v_pk_fma_f32 v[184:185], v[184:185], v[16:17], v[24:25]
    v_pk_fma_f32 v[186:187], v[186:187], v[18:19], v[26:27]
    v_pk_fma_f32 v[188:189], v[188:189], v[20:21], v[28:29]
    v_pk_fma_f32 v[190:191], v[190:191], v[22:23], v[30:31]
    v_pk_fma_f32 v[32:33], v[184:185], v[184:185], s[24:25]
    v_pk_fma_f32 v[34:35], v[186:187], v[186:187], s[24:25]
    v_pk_fma_f32 v[36:37], v[188:189], v[188:189], s[24:25]
    v_pk_fma_f32 v[38:39], v[190:191], v[190:191], s[24:25]
    v_pk_mul_f32 v[32:33], v[32:33], v[184:185] neg_lo:[1,0] neg_hi:[1,0]
    v_pk_mul_f32 v[34:35], v[34:35], v[186:187] neg_lo:[1,0] neg_hi:[1,0]
    v_pk_mul_f32 v[36:37], v[36:37], v[188:189] neg_lo:[1,0] neg_hi:[1,0]
    v_pk_mul_f32 v[38:39], v[38:39], v[190:191] neg_lo:[1,0] neg_hi:[1,0]
    v_exp_f32 v32, v32
    v_exp_f32 v33, v33
    v_exp_f32 v34, v34
    v_exp_f32 v35, v35
    v_exp_f32 v36, v36
    v_exp_f32 v37, v37
    v_exp_f32 v38, v38
    v_exp_f32 v39, v39
    v_pk_fma_f32 v[32:33], v[32:33], s[26:27], s[26:27]
    v_pk_fma_f32 v[34:35], v[34:35], s[26:27], s[26:27]
    v_pk_fma_f32 v[36:37], v[36:37], s[26:27], s[26:27]
    v_pk_fma_f32 v[38:39], v[38:39], s[26:27], s[26:27]
    v_rcp_f32 v32, v32
    v_rcp_f32 v33, v33
    v_rcp_f32 v34, v34
    v_rcp_f32 v35, v35
    v_rcp_f32 v36, v36
    v_rcp_f32 v37, v37
    v_rcp_f32 v38, v38
    v_rcp_f32 v39, v39
    v_pk_mul_f32 v[32:33], v[32:33], v[184:185]
    v_pk_mul_f32 v[34:35], v[34:35], v[186:187]
    v_pk_mul_f32 v[36:37], v[36:37], v[188:189]
    v_pk_mul_f32 v[38:39], v[38:39], v[190:191]
    v_cvt_pk_bf16_f32 v44, v32, v33
    v_cvt_pk_bf16_f32 v45, v34, v35
    v_cvt_pk_bf16_f32 v46, v36, v37
    v_cvt_pk_bf16_f32 v47, v38, v39
    buffer_store_dwordx4 v[44:47], v63, s[16:19], 0 offen sc1
    v_pk_fma_f32 v[176:177], v[176:177], v[16:17], v[24:25]
    v_pk_fma_f32 v[178:179], v[178:179], v[18:19], v[26:27]
    v_pk_fma_f32 v[180:181], v[180:181], v[20:21], v[28:29]
    v_pk_fma_f32 v[182:183], v[182:183], v[22:23], v[30:31]
    v_pk_fma_f32 v[32:33], v[176:177], v[176:177], s[24:25]
    v_pk_fma_f32 v[34:35], v[178:179], v[178:179], s[24:25]
    v_pk_fma_f32 v[36:37], v[180:181], v[180:181], s[24:25]
    v_pk_fma_f32 v[38:39], v[182:183], v[182:183], s[24:25]
    v_pk_mul_f32 v[32:33], v[32:33], v[176:177] neg_lo:[1,0] neg_hi:[1,0]
    v_pk_mul_f32 v[34:35], v[34:35], v[178:179] neg_lo:[1,0] neg_hi:[1,0]
    v_pk_mul_f32 v[36:37], v[36:37], v[180:181] neg_lo:[1,0] neg_hi:[1,0]
    v_pk_mul_f32 v[38:39], v[38:39], v[182:183] neg_lo:[1,0] neg_hi:[1,0]
    v_exp_f32 v32, v32
    v_exp_f32 v33, v33
    v_exp_f32 v34, v34
    v_exp_f32 v35, v35
    v_exp_f32 v36, v36
    v_exp_f32 v37, v37
    v_exp_f32 v38, v38
    v_exp_f32 v39, v39
    v_pk_fma_f32 v[32:33], v[32:33], s[26:27], s[26:27]
    v_pk_fma_f32 v[34:35], v[34:35], s[26:27], s[26:27]
    v_pk_fma_f32 v[36:37], v[36:37], s[26:27], s[26:27]
    v_pk_fma_f32 v[38:39], v[38:39], s[26:27], s[26:27]
    v_rcp_f32 v32, v32
    v_rcp_f32 v33, v33
    v_rcp_f32 v34, v34
    v_rcp_f32 v35, v35
    v_rcp_f32 v36, v36
    v_rcp_f32 v37, v37
    v_rcp_f32 v38, v38
    v_rcp_f32 v39, v39
    v_pk_mul_f32 v[32:33], v[32:33], v[176:177]
    v_pk_mul_f32 v[34:35], v[34:35], v[178:179]
    v_pk_mul_f32 v[36:37], v[36:37], v[180:181]
    v_pk_mul_f32 v[38:39], v[38:39], v[182:183]
    v_cvt_pk_bf16_f32 v40, v32, v33
    v_cvt_pk_bf16_f32 v41, v34, v35
    v_cvt_pk_bf16_f32 v42, v36, v37
    v_cvt_pk_bf16_f32 v43, v38, v39
    buffer_store_dwordx4 v[40:43], v62, s[16:19], 0 offen sc1
L_g2:
    v_pk_fma_f32 v[168:169], v[168:169], v[16:17], v[24:25]
    v_pk_fma_f32 v[170:171], v[170:171], v[18:19], v[26:27]
    v_pk_fma_f32 v[172:173], v[172:173], v[20:21], v[28:29]
    v_pk_fma_f32 v[174:175], v[174:175], v[22:23], v[30:31]
    v_pk_fma_f32 v[32:33], v[168:169], v[168:169], s[24:25]
    v_pk_fma_f32 v[34:35], v[170:171], v[170:171], s[24:25]
    v_pk_fma_f32 v[36:37], v[172:173], v[172:173], s[24:25]
    v_pk_fma_f32 v[38:39], v[174:175], v[174:175], s[24:25]
    v_pk_mul_f32 v[32:33], v[32:33], v[168:169] neg_lo:[1,0] neg_hi:[1,0]
    v_pk_mul_f32 v[34:35], v[34:35], v[170:171] neg_lo:[1,0] neg_hi:[1,0]
    v_pk_mul_f32 v[36:37], v[36:37], v[172:173] neg_lo:[1,0] neg_hi:[1,0]
    v_pk_mul_f32 v[38:39], v[38:39], v[174:175] neg_lo:[1,0] neg_hi:[1,0]
    v_exp_f32 v32, v32
    v_exp_f32 v33, v33
    v_exp_f32 v34, v34
    v_exp_f32 v35, v35
    v_exp_f32 v36, v36
    v_exp_f32 v37, v37
    v_exp_f32 v38, v38
    v_exp_f32 v39, v39
    v_pk_fma_f32 v[32:33], v[32:33], s[26:27], s[26:27]
    v_pk_fma_f32 v[34:35], v[34:35], s[26:27], s[26:27]
    v_pk_fma_f32 v[36:37], v[36:37], s[26:27], s[26:27]
    v_pk_fma_f32 v[38:39], v[38:39], s[26:27], s[26:27]
    v_rcp_f32 v32, v32
    v_rcp_f32 v33, v33
    v_rcp_f32 v34, v34
    v_rcp_f32 v35, v35
    v_rcp_f32 v36, v36
    v_rcp_f32 v37, v37
    v_rcp_f32 v38, v38
    v_rcp_f32 v39, v39
    v_pk_mul_f32 v[32:33], v[32:33], v[168:169]
    v_pk_mul_f32 v[34:35], v[34:35], v[170:171]
    v_pk_mul_f32 v[36:37], v[36:37], v[172:173]
    v_pk_mul_f32 v[38:39], v[38:39], v[174:175]
    v_cvt_pk_bf16_f32 v44, v32, v33
    v_cvt_pk_bf16_f32 v45, v34, v35
    v_cvt_pk_bf16_f32 v46, v36, v37
    v_cvt_pk_bf16_f32 v47, v38, v39
    buffer_store_dwordx4 v[44:47], v61, s[16:19], 0 offen sc1
    v_pk_fma_f32 v[160:161], v[160:161], v[16:17], v[24:25]
    v_pk_fma_f32 v[162:163], v[162:163], v[18:19], v[26:27]
    v_pk_fma_f32 v[164:165], v[164:165], v[20:21], v[28:29]
    v_pk_fma_f32 v[166:167], v[166:167], v[22:23], v[30:31]
    v_pk_fma_f32 v[32:33], v[160:161], v[160:161], s[24:25]
    v_pk_fma_f32 v[34:35], v[162:163], v[162:163], s[24:25]
    v_pk_fma_f32 v[36:37], v[164:165], v[164:165], s[24:25]
    v_pk_fma_f32 v[38:39], v[166:167], v[166:167], s[24:25]
    v_pk_mul_f32 v[32:33], v[32:33], v[160:161] neg_lo:[1,0] neg_hi:[1,0]
    v_pk_mul_f32 v[34:35], v[34:35], v[162:163] neg_lo:[1,0] neg_hi:[1,0]
    v_pk_mul_f32 v[36:37], v[36:37], v[164:165] neg_lo:[1,0] neg_hi:[1,0]
    v_pk_mul_f32 v[38:39], v[38:39], v[166:167] neg_lo:[1,0] neg_hi:[1,0]
    v_exp_f32 v32, v32
    v_exp_f32 v33, v33
    v_exp_f32 v34, v34
    v_exp_f32 v35, v35
    v_exp_f32 v36, v36
    v_exp_f32 v37, v37
    v_exp_f32 v38, v38
    v_exp_f32 v39, v39
    v_pk_fma_f32 v[32:33], v[32:33], s[26:27], s[26:27]
    v_pk_fma_f32 v[34:35], v[34:35], s[26:27], s[26:27]
    v_pk_fma_f32 v[36:37], v[36:37], s[26:27], s[26:27]
    v_pk_fma_f32 v[38:39], v[38:39], s[26:27], s[26:27]
    v_rcp_f32 v32, v32
    v_rcp_f32 v33, v33
    v_rcp_f32 v34, v34
    v_rcp_f32 v35, v35
    v_rcp_f32 v36, v36
    v_rcp_f32 v37, v37
    v_rcp_f32 v38, v38
    v_rcp_f32 v39, v39
    v_pk_mul_f32 v[32:33], v[32:33], v[160:161]
    v_pk_mul_f32 v[34:35], v[34:35], v[162:163]
    v_pk_mul_f32 v[36:37], v[36:37], v[164:165]
    v_pk_mul_f32 v[38:39], v[38:39], v[166:167]
    v_cvt_pk_bf16_f32 v40, v32, v33
    v_cvt_pk_bf16_f32 v41, v34, v35
    v_cvt_pk_bf16_f32 v42, v36, v37
    v_cvt_pk_bf16_f32 v43, v38, v39
    buffer_store_dwordx4 v[40:43], v10, s[16:19], 0 offen sc1
    s_cmp_eq_u32 s42, 0
    s_cbranch_scc1 L_fin
    s_mov_b32 s42, 0
    v_add_u32 v8, s40, v6
    v_add_u32 v10, 128, v7
    v_xor_b32 v9, 160, v8
    v_add_u32 v11, 256, v11
    v_add_u32 v14, 8, v14
    v_add_u32 v12, 16, v12
    s_cmp_lt_u32 s3, 6
    s_cbranch_scc1 L_imgwait
    s_branch L_gather
L_fin:
    s_endpgm
.p2align 6
L_cloop:
    s_waitcnt lgkmcnt(1)
    v_mfma_f32_16x16x32_bf16 v[128:131], v[32:35], v[64:67], v[128:131]
    ds_read_b128 v[44:47], v16 offset:6144
    v_mfma_f32_16x16x32_bf16 v[128:131], v[36:39], v[80:83], v[128:131]
    ds_read_b64_tr_b16 v[96:97], v22 offset:0
    v_mfma_f32_16x16x32_bf16 v[132:135], v[36:39], v[84:87], v[132:135]
    ds_read_b64_tr_b16 v[98:99], v22 offset:1024
    v_mfma_f32_16x16x32_bf16 v[132:135], v[32:35], v[68:71], v[132:135]
    ds_read_b64_tr_b16 v[112:113], v22 offset:8192
    v_mfma_f32_16x16x32_bf16 v[136:139], v[32:35], v[72:75], v[136:139]
    ds_read_b64_tr_b16 v[114:115], v22 offset:9216
    v_mfma_f32_16x16x32_bf16 v[136:139], v[36:39], v[88:91], v[136:139]
    v_mfma_f32_16x16x32_bf16 v[140:143], v[36:39], v[92:95], v[140:143]
    v_mfma_f32_16x16x32_bf16 v[140:143], v[32:35], v[76:79], v[140:143]
    s_waitcnt lgkmcnt(5)
    v_mfma_f32_16x16x32_bf16 v[144:147], v[36:39], v[64:67], v[144:147]
    ds_read_b128 v[48:51], v16 offset:8192
    v_mfma_f32_16x16x32_bf16 v[144:147], v[40:43], v[80:83], v[144:147]
    ds_read_b64_tr_b16 v[100:101], v23 offset:0
    v_mfma_f32_16x16x32_bf16 v[148:151], v[40:43], v[84:87], v[148:151]
    ds_read_b64_tr_b16 v[102:103], v23 offset:1024
    v_mfma_f32_16x16x32_bf16 v[148:151], v[36:39], v[68:71], v[148:151]
    ds_read_b64_tr_b16 v[116:117], v23 offset:8192
    v_mfma_f32_16x16x32_bf16 v[152:155], v[36:39], v[72:75], v[152:155]
    ds_read_b64_tr_b16 v[118:119], v23 offset:9216
    v_mfma_f32_16x16x32_bf16 v[152:155], v[40:43], v[88:91], v[152:155]
    v_mfma_f32_16x16x32_bf16 v[156:159], v[40:43], v[92:95], v[156:159]
    v_mfma_f32_16x16x32_bf16 v[156:159], v[36:39], v[76:79], v[156:159]
    s_waitcnt lgkmcnt(9)
    v_mfma_f32_16x16x32_bf16 v[160:163], v[40:43], v[64:67], v[160:163]
    ds_read_b128 v[52:55], v16 offset:10240
    v_mfma_f32_16x16x32_bf16 v[160:163], v[44:47], v[80:83], v[160:163]
    ds_read_b64_tr_b16 v[104:105], v24 offset:0
    v_mfma_f32_16x16x32_bf16 v[164:167], v[44:47], v[84:87], v[164:167]
    ds_read_b64_tr_b16 v[106:107], v24 offset:1024
    v_mfma_f32_16x16x32_bf16 v[164:167], v[40:43], v[68:71], v[164:167]
    ds_read_b64_tr_b16 v[120:121], v24 offset:8192
    v_mfma_f32_16x16x32_bf16 v[168:171], v[40:43], v[72:75], v[168:171]
    ds_read_b64_tr_b16 v[122:123], v24 offset:9216
    v_mfma_f32_16x16x32_bf16 v[168:171], v[44:47], v[88:91], v[168:171]
    v_mfma_f32_16x16x32_bf16 v[172:175], v[44:47], v[92:95], v[172:175]
    v_mfma_f32_16x16x32_bf16 v[172:175], v[40:43], v[76:79], v[172:175]
    s_waitcnt lgkmcnt(9)
    v_mfma_f32_16x16x32_bf16 v[176:179], v[44:47], v[64:67], v[176:179]
    ds_read_b128 v[56:59], v16 offset:12288
    v_mfma_f32_16x16x32_bf16 v[176:179], v[48:51], v[80:83], v[176:179]
    ds_read_b64_tr_b16 v[108:109], v25 offset:0
    v_mfma_f32_16x16x32_bf16 v[180:183], v[48:51], v[84:87], v[180:183]
    ds_read_b64_tr_b16 v[110:111], v25 offset:1024
    v_mfma_f32_16x16x32_bf16 v[180:183], v[44:47], v[68:71], v[180:183]
    ds_read_b64_tr_b16 v[124:125], v25 offset:8192
    v_mfma_f32_16x16x32_bf16 v[184:187], v[44:47], v[72:75], v[184:187]
    ds_read_b64_tr_b16 v[126:127], v25 offset:9216
    v_mfma_f32_16x16x32_bf16 v[184:187], v[48:51], v[88:91], v[184:187]
    v_mfma_f32_16x16x32_bf16 v[188:191], v[48:51], v[92:95], v[188:191]
    v_mfma_f32_16x16x32_bf16 v[188:191], v[44:47], v[76:79], v[188:191]
    s_waitcnt lgkmcnt(9)
    v_mfma_f32_16x16x32_bf16 v[192:195], v[48:51], v[64:67], v[192:195]
    ds_read_b128 v[60:63], v16 offset:14336
    v_mfma_f32_16x16x32_bf16 v[192:195], v[52:55], v[80:83], v[192:195]
    s_add_u32 s56, s56, 16384
    v_mfma_f32_16x16x32_bf16 v[196:199], v[52:55], v[84:87], v[196:199]
    s_cmp_eq_u32 s56, 0x10000
    v_mfma_f32_16x16x32_bf16 v[196:199], v[48:51], v[68:71], v[196:199]
    s_cselect_b32 s58, 0xffff4000, s63
    v_mfma_f32_16x16x32_bf16 v[200:203], v[48:51], v[72:75], v[200:203]
    s_and_b32 s56, s56, 0xffff
    v_mfma_f32_16x16x32_bf16 v[200:203], v[52:55], v[88:91], v[200:203]
    v_mfma_f32_16x16x32_bf16 v[204:207], v[52:55], v[92:95], v[204:207]
    v_mfma_f32_16x16x32_bf16 v[204:207], v[48:51], v[76:79], v[204:207]
    s_waitcnt lgkmcnt(5)
    v_mfma_f32_16x16x32_bf16 v[208:211], v[52:55], v[64:67], v[208:211]
    ds_read_b128 v[32:35], v18
    v_mfma_f32_16x16x32_bf16 v[208:211], v[56:59], v[80:83], v[208:211]
    v_add_u32 v22, s58, v22
    v_mfma_f32_16x16x32_bf16 v[212:215], v[56:59], v[84:87], v[212:215]
    v_mfma_f32_16x16x32_bf16 v[212:215], v[52:55], v[68:71], v[212:215]
    v_add_u32 v23, s58, v23
    v_mfma_f32_16x16x32_bf16 v[216:219], v[52:55], v[72:75], v[216:219]
    v_mfma_f32_16x16x32_bf16 v[216:219], v[56:59], v[88:91], v[216:219]
    v_add_u32 v24, s58, v24
    v_mfma_f32_16x16x32_bf16 v[220:223], v[56:59], v[92:95], v[220:223]
    v_mfma_f32_16x16x32_bf16 v[220:223], v[52:55], v[76:79], v[220:223]
    v_add_u32 v25, s58, v25
    s_waitcnt lgkmcnt(0)
    v_mfma_f32_16x16x32_bf16 v[224:227], v[56:59], v[64:67], v[224:227]
    v_mfma_f32_16x16x32_bf16 v[224:227], v[60:63], v[80:83], v[224:227]
    s_barrier
    v_mfma_f32_16x16x32_bf16 v[228:231], v[60:63], v[84:87], v[228:231]
    ds_read_b128 v[40:43], v17 offset:0
    v_mfma_f32_16x16x32_bf16 v[228:231], v[56:59], v[68:71], v[228:231]
    ds_read_b128 v[44:47], v17 offset:2048
    v_mfma_f32_16x16x32_bf16 v[232:235], v[56:59], v[72:75], v[232:235]
    v_mfma_f32_16x16x32_bf16 v[232:235], v[60:63], v[88:91], v[232:235]
    v_mfma_f32_16x16x32_bf16 v[236:239], v[60:63], v[92:95], v[236:239]
    v_mfma_f32_16x16x32_bf16 v[236:239], v[56:59], v[76:79], v[236:239]
    v_mfma_f32_16x16x32_bf16 v[240:243], v[60:63], v[64:67], v[240:243]
    ds_read_b128 v[48:51], v17 offset:4096
    v_mfma_f32_16x16x32_bf16 v[240:243], v[32:35], v[80:83], v[240:243]
    v_mfma_f32_16x16x32_bf16 v[244:247], v[32:35], v[84:87], v[244:247]
    v_mfma_f32_16x16x32_bf16 v[244:247], v[60:63], v[68:71], v[244:247]
    v_mfma_f32_16x16x32_bf16 v[248:251], v[60:63], v[72:75], v[248:251]
    v_mfma_f32_16x16x32_bf16 v[248:251], v[32:35], v[88:91], v[248:251]
    v_mfma_f32_16x16x32_bf16 v[252:255], v[32:35], v[92:95], v[252:255]
    v_mfma_f32_16x16x32_bf16 v[252:255], v[60:63], v[76:79], v[252:255]
    s_waitcnt lgkmcnt(1)
    v_mfma_f32_16x16x32_bf16 v[128:131], v[40:43], v[96:99], v[128:131]
    ds_read_b128 v[52:55], v17 offset:6144
    v_mfma_f32_16x16x32_bf16 v[128:131], v[44:47], v[112:115], v[128:131]
    ds_read_b64_tr_b16 v[64:65], v22 offset:0
    v_mfma_f32_16x16x32_bf16 v[132:135], v[44:47], v[116:119], v[132:135]
    ds_read_b64_tr_b16 v[66:67], v22 offset:1024
    v_mfma_f32_16x16x32_bf16 v[132:135], v[40:43], v[100:103], v[132:135]
    ds_read_b64_tr_b16 v[80:81], v22 offset:8192
    v_mfma_f32_16x16x32_bf16 v[136:139], v[40:43], v[104:107], v[136:139]
    ds_read_b64_tr_b16 v[82:83], v22 offset:9216
    v_mfma_f32_16x16x32_bf16 v[136:139], v[44:47], v[120:123], v[136:139]
    v_mfma_f32_16x16x32_bf16 v[140:143], v[44:47], v[124:127], v[140:143]
    v_mfma_f32_16x16x32_bf16 v[140:143], v[40:43], v[108:111], v[140:143]
    s_waitcnt lgkmcnt(5)
    v_mfma_f32_16x16x32_bf16 v[144:147], v[44:47], v[96:99], v[144:147]
    ds_read_b128 v[56:59], v17 offset:8192
    v_mfma_f32_16x16x32_bf16 v[144:147], v[48:51], v[112:115], v[144:147]
    ds_read_b64_tr_b16 v[68:69], v23 offset:0
    v_mfma_f32_16x16x32_bf16 v[148:151], v[48:51], v[116:119], v[148:151]
    ds_read_b64_tr_b16 v[70:71], v23 offset:1024
    v_mfma_f32_16x16x32_bf16 v[148:151], v[44:47], v[100:103], v[148:151]
    ds_read_b64_tr_b16 v[84:85], v23 offset:8192
    v_mfma_f32_16x16x32_bf16 v[152:155], v[44:47], v[104:107], v[152:155]
    ds_read_b64_tr_b16 v[86:87], v23 offset:9216
    v_mfma_f32_16x16x32_bf16 v[152:155], v[48:51], v[120:123], v[152:155]
    v_mfma_f32_16x16x32_bf16 v[156:159], v[48:51], v[124:127], v[156:159]
    v_mfma_f32_16x16x32_bf16 v[156:159], v[44:47], v[108:111], v[156:159]
    s_waitcnt lgkmcnt(9)
    v_mfma_f32_16x16x32_bf16 v[160:163], v[48:51], v[96:99], v[160:163]
    ds_read_b128 v[60:63], v17 offset:10240
    v_mfma_f32_16x16x32_bf16 v[160:163], v[52:55], v[112:115], v[160:163]
    ds_read_b64_tr_b16 v[72:73], v24 offset:0
    v_mfma_f32_16x16x32_bf16 v[164:167], v[52:55], v[116:119], v[164:167]
    ds_read_b64_tr_b16 v[74:75], v24 offset:1024
    v_mfma_f32_16x16x32_bf16 v[164:167], v[48:51], v[100:103], v[164:167]
    ds_read_b64_tr_b16 v[88:89], v24 offset:8192
    v_mfma_f32_16x16x32_bf16 v[168:171], v[48:51], v[104:107], v[168:171]
    ds_read_b64_tr_b16 v[90:91], v24 offset:9216
    v_mfma_f32_16x16x32_bf16 v[168:171], v[52:55], v[120:123], v[168:171]
    v_mfma_f32_16x16x32_bf16 v[172:175], v[52:55], v[124:127], v[172:175]
    v_mfma_f32_16x16x32_bf16 v[172:175], v[48:51], v[108:111], v[172:175]
    s_waitcnt lgkmcnt(9)
    v_mfma_f32_16x16x32_bf16 v[176:179], v[52:55], v[96:99], v[176:179]
    ds_read_b128 v[32:35], v17 offset:12288
    v_mfma_f32_16x16x32_bf16 v[176:179], v[56:59], v[112:115], v[176:179]
    ds_read_b64_tr_b16 v[76:77], v25 offset:0
    v_mfma_f32_16x16x32_bf16 v[180:183], v[56:59], v[116:119], v[180:183]
    ds_read_b64_tr_b16 v[78:79], v25 offset:1024
    v_mfma_f32_16x16x32_bf16 v[180:183], v[52:55], v[100:103], v[180:183]
    ds_read_b64_tr_b16 v[92:93], v25 offset:8192
    v_mfma_f32_16x16x32_bf16 v[184:187], v[52:55], v[104:107], v[184:187]
    ds_read_b64_tr_b16 v[94:95], v25 offset:9216
    v_mfma_f32_16x16x32_bf16 v[184:187], v[56:59], v[120:123], v[184:187]
    v_mfma_f32_16x16x32_bf16 v[188:191], v[56:59], v[124:127], v[188:191]
    v_mfma_f32_16x16x32_bf16 v[188:191], v[52:55], v[108:111], v[188:191]
    s_waitcnt lgkmcnt(9)
    v_mfma_f32_16x16x32_bf16 v[192:195], v[56:59], v[96:99], v[192:195]
    ds_read_b128 v[36:39], v17 offset:14336
    v_mfma_f32_16x16x32_bf16 v[192:195], v[60:63], v[112:115], v[192:195]
    s_add_u32 s56, s56, 16384
    v_mfma_f32_16x16x32_bf16 v[196:199], v[60:63], v[116:119], v[196:199]
    s_cmp_eq_u32 s56, 0x10000
    v_mfma_f32_16x16x32_bf16 v[196:199], v[56:59], v[100:103], v[196:199]
    s_cselect_b32 s58, 0xffff4000, s63
    v_mfma_f32_16x16x32_bf16 v[200:203], v[56:59], v[104:107], v[200:203]
    s_and_b32 s56, s56, 0xffff
    v_mfma_f32_16x16x32_bf16 v[200:203], v[60:63], v[120:123], v[200:203]
    v_mfma_f32_16x16x32_bf16 v[204:207], v[60:63], v[124:127], v[204:207]
    v_mfma_f32_16x16x32_bf16 v[204:207], v[56:59], v[108:111], v[204:207]
    s_waitcnt lgkmcnt(5)
    v_mfma_f32_16x16x32_bf16 v[208:211], v[60:63], v[96:99], v[208:211]
    ds_read_b128 v[40:43], v19
    v_mfma_f32_16x16x32_bf16 v[208:211], v[32:35], v[112:115], v[208:211]
    v_add_u32 v22, s58, v22
    v_mfma_f32_16x16x32_bf16 v[212:215], v[32:35], v[116:119], v[212:215]
    v_mfma_f32_16x16x32_bf16 v[212:215], v[60:63], v[100:103], v[212:215]
    v_add_u32 v23, s58, v23
    v_mfma_f32_16x16x32_bf16 v[216:219], v[60:63], v[104:107], v[216:219]
    v_mfma_f32_16x16x32_bf16 v[216:219], v[32:35], v[120:123], v[216:219]
    v_add_u32 v24, s58, v24
    v_mfma_f32_16x16x32_bf16 v[220:223], v[32:35], v[124:127], v[220:223]
    v_mfma_f32_16x16x32_bf16 v[220:223], v[60:63], v[108:111], v[220:223]
    v_add_u32 v25, s58, v25
    s_waitcnt lgkmcnt(0)
    v_mfma_f32_16x16x32_bf16 v[224:227], v[32:35], v[96:99], v[224:227]
    v_mfma_f32_16x16x32_bf16 v[224:227], v[36:39], v[112:115], v[224:227]
    s_barrier
    v_mfma_f32_16x16x32_bf16 v[228:231], v[36:39], v[116:119], v[228:231]
    ds_read_b128 v[48:51], v20 offset:0
    v_mfma_f32_16x16x32_bf16 v[228:231], v[32:35], v[100:103], v[228:231]
    ds_read_b128 v[52:55], v21 offset:0
    v_mfma_f32_16x16x32_bf16 v[232:235], v[32:35], v[104:107], v[232:235]
    s_add_u32 s59, s54, s55
    v_mfma_f32_16x16x32_bf16 v[232:235], v[36:39], v[120:123], v[232:235]
    s_sub_u32 s59, 98304, s59
    v_mfma_f32_16x16x32_bf16 v[236:239], v[36:39], v[124:127], v[236:239]
    s_sub_u32 s60, s59, s54
    v_mfma_f32_16x16x32_bf16 v[236:239], v[32:35], v[108:111], v[236:239]
    v_mfma_f32_16x16x32_bf16 v[240:243], v[36:39], v[96:99], v[240:243]
    ds_read_b128 v[56:59], v20 offset:2048
    v_mfma_f32_16x16x32_bf16 v[240:243], v[40:43], v[112:115], v[240:243]
    v_add_u32 v16, s60, v16
    v_mfma_f32_16x16x32_bf16 v[244:247], v[40:43], v[116:119], v[244:247]
    ds_read_b128 v[60:63], v21 offset:2048
    v_mfma_f32_16x16x32_bf16 v[244:247], v[36:39], v[100:103], v[244:247]
    v_add_u32 v17, s60, v17
    v_mfma_f32_16x16x32_bf16 v[248:251], v[36:39], v[104:107], v[248:251]
    v_mfma_f32_16x16x32_bf16 v[248:251], v[40:43], v[120:123], v[248:251]
    v_add_u32 v18, s60, v18
    v_mfma_f32_16x16x32_bf16 v[252:255], v[40:43], v[124:127], v[252:255]
    v_mfma_f32_16x16x32_bf16 v[252:255], v[36:39], v[108:111], v[252:255]
    v_add_u32 v19, s60, v19
    s_waitcnt lgkmcnt(2)
    v_mfma_f32_16x16x32_bf16 v[128:131], v[48:51], v[64:67], v[128:131]
    ds_read_b128 v[32:35], v20 offset:4096
    v_mfma_f32_16x16x32_bf16 v[128:131], v[52:55], v[80:83], v[128:131]
    ds_read_b128 v[36:39], v21 offset:4096
    v_mfma_f32_16x16x32_bf16 v[132:135], v[52:55], v[84:87], v[132:135]
    ds_read_b64_tr_b16 v[96:97], v22 offset:0
    v_mfma_f32_16x16x32_bf16 v[132:135], v[48:51], v[68:71], v[132:135]
    ds_read_b64_tr_b16 v[98:99], v22 offset:1024
    v_mfma_f32_16x16x32_bf16 v[136:139], v[48:51], v[72:75], v[136:139]
    ds_read_b64_tr_b16 v[112:113], v22 offset:8192
    v_mfma_f32_16x16x32_bf16 v[136:139], v[52:55], v[88:91], v[136:139]
    ds_read_b64_tr_b16 v[114:115], v22 offset:9216
    v_mfma_f32_16x16x32_bf16 v[140:143], v[52:55], v[92:95], v[140:143]
    v_mfma_f32_16x16x32_bf16 v[140:143], v[48:51], v[76:79], v[140:143]
    s_waitcnt lgkmcnt(6)
    v_mfma_f32_16x16x32_bf16 v[144:147], v[56:59], v[64:67], v[144:147]
    ds_read_b128 v[40:43], v20 offset:6144
    v_mfma_f32_16x16x32_bf16 v[144:147], v[60:63], v[80:83], v[144:147]
    ds_read_b128 v[44:47], v21 offset:6144
    v_mfma_f32_16x16x32_bf16 v[148:151], v[60:63], v[84:87], v[148:151]
    ds_read_b64_tr_b16 v[100:101], v23 offset:0
    v_mfma_f32_16x16x32_bf16 v[148:151], v[56:59], v[68:71], v[148:151]
    ds_read_b64_tr_b16 v[102:103], v23 offset:1024
    v_mfma_f32_16x16x32_bf16 v[152:155], v[56:59], v[72:75], v[152:155]
    ds_read_b64_tr_b16 v[116:117], v23 offset:8192
    v_mfma_f32_16x16x32_bf16 v[152:155], v[60:63], v[88:91], v[152:155]
    ds_read_b64_tr_b16 v[118:119], v23 offset:9216
    v_mfma_f32_16x16x32_bf16 v[156:159], v[60:63], v[92:95], v[156:159]
    v_mfma_f32_16x16x32_bf16 v[156:159], v[56:59], v[76:79], v[156:159]
    s_waitcnt lgkmcnt(10)
    v_mfma_f32_16x16x32_bf16 v[160:163], v[32:35], v[64:67], v[160:163]
    ds_read_b128 v[48:51], v20 offset:8192
    v_mfma_f32_16x16x32_bf16 v[160:163], v[36:39], v[80:83], v[160:163]
    ds_read_b128 v[52:55], v21 offset:8192
    v_mfma_f32_16x16x32_bf16 v[164:167], v[36:39], v[84:87], v[164:167]
    ds_read_b64_tr_b16 v[104:105], v24 offset:0
    v_mfma_f32_16x16x32_bf16 v[164:167], v[32:35], v[68:71], v[164:167]
    ds_read_b64_tr_b16 v[106:107], v24 offset:1024
    v_mfma_f32_16x16x32_bf16 v[168:171], v[32:35], v[72:75], v[168:171]
    ds_read_b64_tr_b16 v[120:121], v24 offset:8192
    v_mfma_f32_16x16x32_bf16 v[168:171], v[36:39], v[88:91], v[168:171]
    ds_read_b64_tr_b16 v[122:123], v24 offset:9216
    v_mfma_f32_16x16x32_bf16 v[172:175], v[36:39], v[92:95], v[172:175]
    v_mfma_f32_16x16x32_bf16 v[172:175], v[32:35], v[76:79], v[172:175]
    s_waitcnt lgkmcnt(10)
    v_mfma_f32_16x16x32_bf16 v[176:179], v[40:43], v[64:67], v[176:179]
    ds_read_b128 v[56:59], v20 offset:10240
    v_mfma_f32_16x16x32_bf16 v[176:179], v[44:47], v[80:83], v[176:179]
    ds_read_b128 v[60:63], v21 offset:10240
    v_mfma_f32_16x16x32_bf16 v[180:183], v[44:47], v[84:87], v[180:183]
    ds_read_b64_tr_b16 v[108:109], v25 offset:0
    v_mfma_f32_16x16x32_bf16 v[180:183], v[40:43], v[68:71], v[180:183]
    ds_read_b64_tr_b16 v[110:111], v25 offset:1024
    v_mfma_f32_16x16x32_bf16 v[184:187], v[40:43], v[72:75], v[184:187]
    ds_read_b64_tr_b16 v[124:125], v25 offset:8192
    v_mfma_f32_16x16x32_bf16 v[184:187], v[44:47], v[88:91], v[184:187]
    ds_read_b64_tr_b16 v[126:127], v25 offset:9216
    v_mfma_f32_16x16x32_bf16 v[188:191], v[44:47], v[92:95], v[188:191]
    v_mfma_f32_16x16x32_bf16 v[188:191], v[40:43], v[76:79], v[188:191]
    s_waitcnt lgkmcnt(10)
    v_mfma_f32_16x16x32_bf16 v[192:195], v[48:51], v[64:67], v[192:195]
    ds_read_b128 v[32:35], v20 offset:12288
    v_mfma_f32_16x16x32_bf16 v[192:195], v[52:55], v[80:83], v[192:195]
    ds_read_b128 v[36:39], v21 offset:12288
    v_mfma_f32_16x16x32_bf16 v[196:199], v[52:55], v[84:87], v[196:199]
    s_add_u32 s56, s56, 16384
    v_mfma_f32_16x16x32_bf16 v[196:199], v[48:51], v[68:71], v[196:199]
    s_cmp_eq_u32 s56, 0x10000
    v_mfma_f32_16x16x32_bf16 v[200:203], v[48:51], v[72:75], v[200:203]
    s_cselect_b32 s58, 0xffff4000, s63
    v_mfma_f32_16x16x32_bf16 v[200:203], v[52:55], v[88:91], v[200:203]
    s_and_b32 s56, s56, 0xffff
    v_mfma_f32_16x16x32_bf16 v[204:207], v[52:55], v[92:95], v[204:207]
    v_mfma_f32_16x16x32_bf16 v[204:207], v[48:51], v[76:79], v[204:207]
    s_waitcnt lgkmcnt(6)
    v_mfma_f32_16x16x32_bf16 v[208:211], v[56:59], v[64:67], v[208:211]
    ds_read_b128 v[40:43], v20 offset:14336
    v_mfma_f32_16x16x32_bf16 v[208:211], v[60:63], v[80:83], v[208:211]
    v_add_u32 v22, s58, v22
    v_mfma_f32_16x16x32_bf16 v[212:215], v[60:63], v[84:87], v[212:215]
    ds_read_b128 v[44:47], v21 offset:14336
    v_mfma_f32_16x16x32_bf16 v[212:215], v[56:59], v[68:71], v[212:215]
    v_add_u32 v23, s58, v23
    v_mfma_f32_16x16x32_bf16 v[216:219], v[56:59], v[72:75], v[216:219]
    v_mfma_f32_16x16x32_bf16 v[216:219], v[60:63], v[88:91], v[216:219]
    v_add_u32 v24, s58, v24
    v_mfma_f32_16x16x32_bf16 v[220:223], v[60:63], v[92:95], v[220:223]
    v_mfma_f32_16x16x32_bf16 v[220:223], v[56:59], v[76:79], v[220:223]
    v_add_u32 v25, s58, v25
    s_waitcnt lgkmcnt(0)
    v_mfma_f32_16x16x32_bf16 v[224:227], v[32:35], v[64:67], v[224:227]
    v_mfma_f32_16x16x32_bf16 v[224:227], v[36:39], v[80:83], v[224:227]
    s_barrier
    v_mfma_f32_16x16x32_bf16 v[228:231], v[36:39], v[84:87], v[228:231]
    ds_read_b128 v[48:51], v16 offset:0
    v_mfma_f32_16x16x32_bf16 v[228:231], v[32:35], v[68:71], v[228:231]
    ds_read_b128 v[52:55], v16 offset:2048
    v_mfma_f32_16x16x32_bf16 v[232:235], v[32:35], v[72:75], v[232:235]
    s_sub_u32 s60, s54, s55
    v_mfma_f32_16x16x32_bf16 v[232:235], v[36:39], v[88:91], v[232:235]
    s_mov_b32 s55, s54
    v_mfma_f32_16x16x32_bf16 v[236:239], v[36:39], v[92:95], v[236:239]
    s_mov_b32 s54, s59
    v_mfma_f32_16x16x32_bf16 v[236:239], v[32:35], v[76:79], v[236:239]
    v_mfma_f32_16x16x32_bf16 v[240:243], v[40:43], v[64:67], v[240:243]
    ds_read_b128 v[56:59], v16 offset:4096
    v_mfma_f32_16x16x32_bf16 v[240:243], v[44:47], v[80:83], v[240:243]
    v_add_u32 v20, s60, v20
    v_mfma_f32_16x16x32_bf16 v[244:247], v[44:47], v[84:87], v[244:247]
    v_mfma_f32_16x16x32_bf16 v[244:247], v[40:43], v[68:71], v[244:247]
    v_add_u32 v21, s60, v21
    v_mfma_f32_16x16x32_bf16 v[248:251], v[40:43], v[72:75], v[248:251]
    s_sub_u32 s57, s57, 1
    v_mfma_f32_16x16x32_bf16 v[248:251], v[44:47], v[88:91], v[248:251]
    s_cmp_eq_u32 s57, 0
    v_mfma_f32_16x16x32_bf16 v[252:255], v[44:47], v[92:95], v[252:255]
    v_mfma_f32_16x16x32_bf16 v[252:255], v[40:43], v[76:79], v[252:255]
    s_cbranch_scc1 L_clast
    s_waitcnt lgkmcnt(1)
    v_mfma_f32_16x16x32_bf16 v[128:131], v[48:51], v[96:99], v[128:131]
    ds_read_b128 v[60:63], v16 offset:6144
    v_mfma_f32_16x16x32_bf16 v[128:131], v[52:55], v[112:115], v[128:131]
    ds_read_b64_tr_b16 v[64:65], v22 offset:0
    v_mfma_f32_16x16x32_bf16 v[132:135], v[52:55], v[116:119], v[132:135]
    ds_read_b64_tr_b16 v[66:67], v22 offset:1024
    v_mfma_f32_16x16x32_bf16 v[132:135], v[48:51], v[100:103], v[132:135]
    ds_read_b64_tr_b16 v[80:81], v22 offset:8192
    v_mfma_f32_16x16x32_bf16 v[136:139], v[48:51], v[104:107], v[136:139]
    ds_read_b64_tr_b16 v[82:83], v22 offset:9216
    v_mfma_f32_16x16x32_bf16 v[136:139], v[52:55], v[120:123], v[136:139]
    v_mfma_f32_16x16x32_bf16 v[140:143], v[52:55], v[124:127], v[140:143]
    v_mfma_f32_16x16x32_bf16 v[140:143], v[48:51], v[108:111], v[140:143]
    s_waitcnt lgkmcnt(5)
    v_mfma_f32_16x16x32_bf16 v[144:147], v[52:55], v[96:99], v[144:147]
    ds_read_b128 v[32:35], v16 offset:8192
    v_mfma_f32_16x16x32_bf16 v[144:147], v[56:59], v[112:115], v[144:147]
    ds_read_b64_tr_b16 v[68:69], v23 offset:0
    v_mfma_f32_16x16x32_bf16 v[148:151], v[56:59], v[116:119], v[148:151]
    ds_read_b64_tr_b16 v[70:71], v23 offset:1024
    v_mfma_f32_16x16x32_bf16 v[148:151], v[52:55], v[100:103], v[148:151]
    ds_read_b64_tr_b16 v[84:85], v23 offset:8192
    v_mfma_f32_16x16x32_bf16 v[152:155], v[52:55], v[104:107], v[152:155]
    ds_read_b64_tr_b16 v[86:87], v23 offset:9216
    v_mfma_f32_16x16x32_bf16 v[152:155], v[56:59], v[120:123], v[152:155]
    v_mfma_f32_16x16x32_bf16 v[156:159], v[56:59], v[124:127], v[156:159]
    v_mfma_f32_16x16x32_bf16 v[156:159], v[52:55], v[108:111], v[156:159]
    s_waitcnt lgkmcnt(9)
    v_mfma_f32_16x16x32_bf16 v[160:163], v[56:59], v[96:99], v[160:163]
    ds_read_b128 v[36:39], v16 offset:10240
    v_mfma_f32_16x16x32_bf16 v[160:163], v[60:63], v[112:115], v[160:163]
    ds_read_b64_tr_b16 v[72:73], v24 offset:0
    v_mfma_f32_16x16x32_bf16 v[164:167], v[60:63], v[116:119], v[164:167]
    ds_read_b64_tr_b16 v[74:75], v24 offset:1024
    v_mfma_f32_16x16x32_bf16 v[164:167], v[56:59], v[100:103], v[164:167]
    ds_read_b64_tr_b16 v[88:89], v24 offset:8192
    v_mfma_f32_16x16x32_bf16 v[168:171], v[56:59], v[104:107], v[168:171]
    ds_read_b64_tr_b16 v[90:91], v24 offset:9216
    v_mfma_f32_16x16x32_bf16 v[168:171], v[60:63], v[120:123], v[168:171]
    v_mfma_f32_16x16x32_bf16 v[172:175], v[60:63], v[124:127], v[172:175]
    v_mfma_f32_16x16x32_bf16 v[172:175], v[56:59], v[108:111], v[172:175]
    s_waitcnt lgkmcnt(9)
    v_mfma_f32_16x16x32_bf16 v[176:179], v[60:63], v[96:99], v[176:179]
    ds_read_b128 v[40:43], v16 offset:12288
    v_mfma_f32_16x16x32_bf16 v[176:179], v[32:35], v[112:115], v[176:179]
    ds_read_b64_tr_b16 v[76:77], v25 offset:0
    v_mfma_f32_16x16x32_bf16 v[180:183], v[32:35], v[116:119], v[180:183]
    ds_read_b64_tr_b16 v[78:79], v25 offset:1024
    v_mfma_f32_16x16x32_bf16 v[180:183], v[60:63], v[100:103], v[180:183]
    ds_read_b64_tr_b16 v[92:93], v25 offset:8192
    v_mfma_f32_16x16x32_bf16 v[184:187], v[60:63], v[104:107], v[184:187]
    ds_read_b64_tr_b16 v[94:95], v25 offset:9216
    v_mfma_f32_16x16x32_bf16 v[184:187], v[32:35], v[120:123], v[184:187]
    v_mfma_f32_16x16x32_bf16 v[188:191], v[32:35], v[124:127], v[188:191]
    v_mfma_f32_16x16x32_bf16 v[188:191], v[60:63], v[108:111], v[188:191]
    s_waitcnt lgkmcnt(9)
    v_mfma_f32_16x16x32_bf16 v[192:195], v[32:35], v[96:99], v[192:195]
    ds_read_b128 v[44:47], v16 offset:14336
    v_mfma_f32_16x16x32_bf16 v[192:195], v[36:39], v[112:115], v[192:195]
    s_add_u32 s56, s56, 16384
    v_mfma_f32_16x16x32_bf16 v[196:199], v[36:39], v[116:119], v[196:199]
    s_cmp_eq_u32 s56, 0x10000
    v_mfma_f32_16x16x32_bf16 v[196:199], v[32:35], v[100:103], v[196:199]
    s_cselect_b32 s58, 0xffff4000, s63
    v_mfma_f32_16x16x32_bf16 v[200:203], v[32:35], v[104:107], v[200:203]
    s_and_b32 s56, s56, 0xffff
    v_mfma_f32_16x16x32_bf16 v[200:203], v[36:39], v[120:123], v[200:203]
    v_mfma_f32_16x16x32_bf16 v[204:207], v[36:39], v[124:127], v[204:207]
    v_mfma_f32_16x16x32_bf16 v[204:207], v[32:35], v[108:111], v[204:207]
    s_waitcnt lgkmcnt(5)
    v_mfma_f32_16x16x32_bf16 v[208:211], v[36:39], v[96:99], v[208:211]
    ds_read_b128 v[48:51], v18
    v_mfma_f32_16x16x32_bf16 v[208:211], v[40:43], v[112:115], v[208:211]
    v_add_u32 v22, s58, v22
    v_mfma_f32_16x16x32_bf16 v[212:215], v[40:43], v[116:119], v[212:215]
    v_mfma_f32_16x16x32_bf16 v[212:215], v[36:39], v[100:103], v[212:215]
    v_add_u32 v23, s58, v23
    v_mfma_f32_16x16x32_bf16 v[216:219], v[36:39], v[104:107], v[216:219]
    v_mfma_f32_16x16x32_bf16 v[216:219], v[40:43], v[120:123], v[216:219]
    v_add_u32 v24, s58, v24
    v_mfma_f32_16x16x32_bf16 v[220:223], v[40:43], v[124:127], v[220:223]
    v_mfma_f32_16x16x32_bf16 v[220:223], v[36:39], v[108:111], v[220:223]
    v_add_u32 v25, s58, v25
    s_waitcnt lgkmcnt(0)
    v_mfma_f32_16x16x32_bf16 v[224:227], v[40:43], v[96:99], v[224:227]
    v_mfma_f32_16x16x32_bf16 v[224:227], v[44:47], v[112:115], v[224:227]
    s_barrier
    v_mfma_f32_16x16x32_bf16 v[228:231], v[44:47], v[116:119], v[228:231]
    ds_read_b128 v[56:59], v17 offset:0
    v_mfma_f32_16x16x32_bf16 v[228:231], v[40:43], v[100:103], v[228:231]
    ds_read_b128 v[60:63], v17 offset:2048
    v_mfma_f32_16x16x32_bf16 v[232:235], v[40:43], v[104:107], v[232:235]
    v_mfma_f32_16x16x32_bf16 v[232:235], v[44:47], v[120:123], v[232:235]
    v_mfma_f32_16x16x32_bf16 v[236:239], v[44:47], v[124:127], v[236:239]
    v_mfma_f32_16x16x32_bf16 v[236:239], v[40:43], v[108:111], v[236:239]
    v_mfma_f32_16x16x32_bf16 v[240:243], v[44:47], v[96:99], v[240:243]
    ds_read_b128 v[32:35], v17 offset:4096
    v_mfma_f32_16x16x32_bf16 v[240:243], v[48:51], v[112:115], v[240:243]
    v_mfma_f32_16x16x32_bf16 v[244:247], v[48:51], v[116:119], v[244:247]
    v_mfma_f32_16x16x32_bf16 v[244:247], v[44:47], v[100:103], v[244:247]
    v_mfma_f32_16x16x32_bf16 v[248:251], v[44:47], v[104:107], v[248:251]
    v_mfma_f32_16x16x32_bf16 v[248:251], v[48:51], v[120:123], v[248:251]
    v_mfma_f32_16x16x32_bf16 v[252:255], v[48:51], v[124:127], v[252:255]
    v_mfma_f32_16x16x32_bf16 v[252:255], v[44:47], v[108:111], v[252:255]
    s_waitcnt lgkmcnt(1)
    v_mfma_f32_16x16x32_bf16 v[128:131], v[56:59], v[64:67], v[128:131]
    ds_read_b128 v[36:39], v17 offset:6144
    v_mfma_f32_16x16x32_bf16 v[128:131], v[60:63], v[80:83], v[128:131]
    ds_read_b64_tr_b16 v[96:97], v22 offset:0
    v_mfma_f32_16x16x32_bf16 v[132:135], v[60:63], v[84:87], v[132:135]
    ds_read_b64_tr_b16 v[98:99], v22 offset:1024
    v_mfma_f32_16x16x32_bf16 v[132:135], v[56:59], v[68:71], v[132:135]
    ds_read_b64_tr_b16 v[112:113], v22 offset:8192
    v_mfma_f32_16x16x32_bf16 v[136:139], v[56:59], v[72:75], v[136:139]
    ds_read_b64_tr_b16 v[114:115], v22 offset:9216
    v_mfma_f32_16x16x32_bf16 v[136:139], v[60:63], v[88:91], v[136:139]
    v_mfma_f32_16x16x32_bf16 v[140:143], v[60:63], v[92:95], v[140:143]
    v_mfma_f32_16x16x32_bf16 v[140:143], v[56:59], v[76:79], v[140:143]
    s_waitcnt lgkmcnt(5)
    v_mfma_f32_16x16x32_bf16 v[144:147], v[60:63], v[64:67], v[144:147]
    ds_read_b128 v[40:43], v17 offset:8192
    v_mfma_f32_16x16x32_bf16 v[144:147], v[32:35], v[80:83], v[144:147]
    ds_read_b64_tr_b16 v[100:101], v23 offset:0
    v_mfma_f32_16x16x32_bf16 v[148:151], v[32:35], v[84:87], v[148:151]
    ds_read_b64_tr_b16 v[102:103], v23 offset:1024
    v_mfma_f32_16x16x32_bf16 v[148:151], v[60:63], v[68:71], v[148:151]
    ds_read_b64_tr_b16 v[116:117], v23 offset:8192
    v_mfma_f32_16x16x32_bf16 v[152:155], v[60:63], v[72:75], v[152:155]
    ds_read_b64_tr_b16 v[118:119], v23 offset:9216
    v_mfma_f32_16x16x32_bf16 v[152:155], v[32:35], v[88:91], v[152:155]
    v_mfma_f32_16x16x32_bf16 v[156:159], v[32:35], v[92:95], v[156:159]
    v_mfma_f32_16x16x32_bf16 v[156:159], v[60:63], v[76:79], v[156:159]
    s_waitcnt lgkmcnt(9)
    v_mfma_f32_16x16x32_bf16 v[160:163], v[32:35], v[64:67], v[160:163]
    ds_read_b128 v[44:47], v17 offset:10240
    v_mfma_f32_16x16x32_bf16 v[160:163], v[36:39], v[80:83], v[160:163]
    ds_read_b64_tr_b16 v[104:105], v24 offset:0
    v_mfma_f32_16x16x32_bf16 v[164:167], v[36:39], v[84:87], v[164:167]
    ds_read_b64_tr_b16 v[106:107], v24 offset:1024
    v_mfma_f32_16x16x32_bf16 v[164:167], v[32:35], v[68:71], v[164:167]
    ds_read_b64_tr_b16 v[120:121], v24 offset:8192
    v_mfma_f32_16x16x32_bf16 v[168:171], v[32:35], v[72:75], v[168:171]
    ds_read_b64_tr_b16 v[122:123], v24 offset:9216
    v_mfma_f32_16x16x32_bf16 v[168:171], v[36:39], v[88:91], v[168:171]
    v_mfma_f32_16x16x32_bf16 v[172:175], v[36:39], v[92:95], v[172:175]
    v_mfma_f32_16x16x32_bf16 v[172:175], v[32:35], v[76:79], v[172:175]
    s_waitcnt lgkmcnt(9)
    v_mfma_f32_16x16x32_bf16 v[176:179], v[36:39], v[64:67], v[176:179]
    ds_read_b128 v[48:51], v17 offset:12288
    v_mfma_f32_16x16x32_bf16 v[176:179], v[40:43], v[80:83], v[176:179]
    ds_read_b64_tr_b16 v[108:109], v25 offset:0
    v_mfma_f32_16x16x32_bf16 v[180:183], v[40:43], v[84:87], v[180:183]
    ds_read_b64_tr_b16 v[110:111], v25 offset:1024
    v_mfma_f32_16x16x32_bf16 v[180:183], v[36:39], v[68:71], v[180:183]
    ds_read_b64_tr_b16 v[124:125], v25 offset:8192
    v_mfma_f32_16x16x32_bf16 v[184:187], v[36:39], v[72:75], v[184:187]
    ds_read_b64_tr_b16 v[126:127], v25 offset:9216
    v_mfma_f32_16x16x32_bf16 v[184:187], v[40:43], v[88:91], v[184:187]
    v_mfma_f32_16x16x32_bf16 v[188:191], v[40:43], v[92:95], v[188:191]
    v_mfma_f32_16x16x32_bf16 v[188:191], v[36:39], v[76:79], v[188:191]
    s_waitcnt lgkmcnt(9)
    v_mfma_f32_16x16x32_bf16 v[192:195], v[40:43], v[64:67], v[192:195]
    ds_read_b128 v[52:55], v17 offset:14336
    v_mfma_f32_16x16x32_bf16 v[192:195], v[44:47], v[80:83], v[192:195]
    s_add_u32 s56, s56, 16384
    v_mfma_f32_16x16x32_bf16 v[196:199], v[44:47], v[84:87], v[196:199]
    s_cmp_eq_u32 s56, 0x10000
    v_mfma_f32_16x16x32_bf16 v[196:199], v[40:43], v[68:71], v[196:199]
    s_cselect_b32 s58, 0xffff4000, s63
    v_mfma_f32_16x16x32_bf16 v[200:203], v[40:43], v[72:75], v[200:203]
    s_and_b32 s56, s56, 0xffff
    v_mfma_f32_16x16x32_bf16 v[200:203], v[44:47], v[88:91], v[200:203]
    v_mfma_f32_16x16x32_bf16 v[204:207], v[44:47], v[92:95], v[204:207]
    v_mfma_f32_16x16x32_bf16 v[204:207], v[40:43], v[76:79], v[204:207]
    s_waitcnt lgkmcnt(5)
    v_mfma_f32_16x16x32_bf16 v[208:211], v[44:47], v[64:67], v[208:211]
    ds_read_b128 v[56:59], v19
    v_mfma_f32_16x16x32_bf16 v[208:211], v[48:51], v[80:83], v[208:211]
    v_add_u32 v22, s58, v22
    v_mfma_f32_16x16x32_bf16 v[212:215], v[48:51], v[84:87], v[212:215]
    v_mfma_f32_16x16x32_bf16 v[212:215], v[44:47], v[68:71], v[212:215]
    v_add_u32 v23, s58, v23
    v_mfma_f32_16x16x32_bf16 v[216:219], v[44:47], v[72:75], v[216:219]
    v_mfma_f32_16x16x32_bf16 v[216:219], v[48:51], v[88:91], v[216:219]
    v_add_u32 v24, s58, v24
    v_mfma_f32_16x16x32_bf16 v[220:223], v[48:51], v[92:95], v[220:223]
    v_mfma_f32_16x16x32_bf16 v[220:223], v[44:47], v[76:79], v[220:223]
    v_add_u32 v25, s58, v25
    s_waitcnt lgkmcnt(0)
    v_mfma_f32_16x16x32_bf16 v[224:227], v[48:51], v[64:67], v[224:227]
    v_mfma_f32_16x16x32_bf16 v[224:227], v[52:55], v[80:83], v[224:227]
    s_barrier
    v_mfma_f32_16x16x32_bf16 v[228:231], v[52:55], v[84:87], v[228:231]
    ds_read_b128 v[32:35], v20 offset:0
    v_mfma_f32_16x16x32_bf16 v[228:231], v[48:51], v[68:71], v[228:231]
    ds_read_b128 v[36:39], v21 offset:0
    v_mfma_f32_16x16x32_bf16 v[232:235], v[48:51], v[72:75], v[232:235]
    s_add_u32 s59, s54, s55
    v_mfma_f32_16x16x32_bf16 v[232:235], v[52:55], v[88:91], v[232:235]
    s_sub_u32 s59, 98304, s59
    v_mfma_f32_16x16x32_bf16 v[236:239], v[52:55], v[92:95], v[236:239]
    s_sub_u32 s60, s59, s54
    v_mfma_f32_16x16x32_bf16 v[236:239], v[48:51], v[76:79], v[236:239]
    v_mfma_f32_16x16x32_bf16 v[240:243], v[52:55], v[64:67], v[240:243]
    ds_read_b128 v[40:43], v20 offset:2048
    v_mfma_f32_16x16x32_bf16 v[240:243], v[56:59], v[80:83], v[240:243]
    v_add_u32 v16, s60, v16
    v_mfma_f32_16x16x32_bf16 v[244:247], v[56:59], v[84:87], v[244:247]
    ds_read_b128 v[44:47], v21 offset:2048
    v_mfma_f32_16x16x32_bf16 v[244:247], v[52:55], v[68:71], v[244:247]
    v_add_u32 v17, s60, v17
    v_mfma_f32_16x16x32_bf16 v[248:251], v[52:55], v[72:75], v[248:251]
    v_mfma_f32_16x16x32_bf16 v[248:251], v[56:59], v[88:91], v[248:251]
    v_add_u32 v18, s60, v18
    v_mfma_f32_16x16x32_bf16 v[252:255], v[56:59], v[92:95], v[252:255]
    v_mfma_f32_16x16x32_bf16 v[252:255], v[52:55], v[76:79], v[252:255]
    v_add_u32 v19, s60, v19
    s_waitcnt lgkmcnt(2)
    v_mfma_f32_16x16x32_bf16 v[128:131], v[32:35], v[96:99], v[128:131]
    ds_read_b128 v[48:51], v20 offset:4096
    v_mfma_f32_16x16x32_bf16 v[128:131], v[36:39], v[112:115], v[128:131]
    ds_read_b128 v[52:55], v21 offset:4096
    v_mfma_f32_16x16x32_bf16 v[132:135], v[36:39], v[116:119], v[132:135]
    ds_read_b64_tr_b16 v[64:65], v22 offset:0
    v_mfma_f32_16x16x32_bf16 v[132:135], v[32:35], v[100:103], v[132:135]
    ds_read_b64_tr_b16 v[66:67], v22 offset:1024
    v_mfma_f32_16x16x32_bf16 v[136:139], v[32:35], v[104:107], v[136:139]
    ds_read_b64_tr_b16 v[80:81], v22 offset:8192
    v_mfma_f32_16x16x32_bf16 v[136:139], v[36:39], v[120:123], v[136:139]
    ds_read_b64_tr_b16 v[82:83], v22 offset:9216
    v_mfma_f32_16x16x32_bf16 v[140:143], v[36:39], v[124:127], v[140:143]
    v_mfma_f32_16x16x32_bf16 v[140:143], v[32:35], v[108:111], v[140:143]
    s_waitcnt lgkmcnt(6)
    v_mfma_f32_16x16x32_bf16 v[144:147], v[40:43], v[96:99], v[144:147]
    ds_read_b128 v[56:59], v20 offset:6144
    v_mfma_f32_16x16x32_bf16 v[144:147], v[44:47], v[112:115], v[144:147]
    ds_read_b128 v[60:63], v21 offset:6144
    v_mfma_f32_16x16x32_bf16 v[148:151], v[44:47], v[116:119], v[148:151]
    ds_read_b64_tr_b16 v[68:69], v23 offset:0
    v_mfma_f32_16x16x32_bf16 v[148:151], v[40:43], v[100:103], v[148:151]
    ds_read_b64_tr_b16 v[70:71], v23 offset:1024
    v_mfma_f32_16x16x32_bf16 v[152:155], v[40:43], v[104:107], v[152:155]
    ds_read_b64_tr_b16 v[84:85], v23 offset:8192
    v_mfma_f32_16x16x32_bf16 v[152:155], v[44:47], v[120:123], v[152:155]
    ds_read_b64_tr_b16 v[86:87], v23 offset:9216
    v_mfma_f32_16x16x32_bf16 v[156:159], v[44:47], v[124:127], v[156:159]
    v_mfma_f32_16x16x32_bf16 v[156:159], v[40:43], v[108:111], v[156:159]
    s_waitcnt lgkmcnt(10)
    v_mfma_f32_16x16x32_bf16 v[160:163], v[48:51], v[96:99], v[160:163]
    ds_read_b128 v[32:35], v20 offset:8192
    v_mfma_f32_16x16x32_bf16 v[160:163], v[52:55], v[112:115], v[160:163]
    ds_read_b128 v[36:39], v21 offset:8192
    v_mfma_f32_16x16x32_bf16 v[164:167], v[52:55], v[116:119], v[164:167]
    ds_read_b64_tr_b16 v[72:73], v24 offset:0
    v_mfma_f32_16x16x32_bf16 v[164:167], v[48:51], v[100:103], v[164:167]
    ds_read_b64_tr_b16 v[74:75], v24 offset:1024
    v_mfma_f32_16x16x32_bf16 v[168:171], v[48:51], v[104:107], v[168:171]
    ds_read_b64_tr_b16 v[88:89], v24 offset:8192
    v_mfma_f32_16x16x32_bf16 v[168:171], v[52:55], v[120:123], v[168:171]
    ds_read_b64_tr_b16 v[90:91], v24 offset:9216
    v_mfma_f32_16x16x32_bf16 v[172:175], v[52:55], v[124:127], v[172:175]
    v_mfma_f32_16x16x32_bf16 v[172:175], v[48:51], v[108:111], v[172:175]
    s_waitcnt lgkmcnt(10)
    v_mfma_f32_16x16x32_bf16 v[176:179], v[56:59], v[96:99], v[176:179]
    ds_read_b128 v[40:43], v20 offset:10240
    v_mfma_f32_16x16x32_bf16 v[176:179], v[60:63], v[112:115], v[176:179]
    ds_read_b128 v[44:47], v21 offset:10240
    v_mfma_f32_16x16x32_bf16 v[180:183], v[60:63], v[116:119], v[180:183]
    ds_read_b64_tr_b16 v[76:77], v25 offset:0
    v_mfma_f32_16x16x32_bf16 v[180:183], v[56:59], v[100:103], v[180:183]
    ds_read_b64_tr_b16 v[78:79], v25 offset:1024
    v_mfma_f32_16x16x32_bf16 v[184:187], v[56:59], v[104:107], v[184:187]
    ds_read_b64_tr_b16 v[92:93], v25 offset:8192
    v_mfma_f32_16x16x32_bf16 v[184:187], v[60:63], v[120:123], v[184:187]
    ds_read_b64_tr_b16 v[94:95], v25 offset:9216
    v_mfma_f32_16x16x32_bf16 v[188:191], v[60:63], v[124:127], v[188:191]
    v_mfma_f32_16x16x32_bf16 v[188:191], v[56:59], v[108:111], v[188:191]
    s_waitcnt lgkmcnt(10)
    v_mfma_f32_16x16x32_bf16 v[192:195], v[32:35], v[96:99], v[192:195]
    ds_read_b128 v[48:51], v20 offset:12288
    v_mfma_f32_16x16x32_bf16 v[192:195], v[36:39], v[112:115], v[192:195]
    ds_read_b128 v[52:55], v21 offset:12288
    v_mfma_f32_16x16x32_bf16 v[196:199], v[36:39], v[116:119], v[196:199]
    s_add_u32 s56, s56, 16384
    v_mfma_f32_16x16x32_bf16 v[196:199], v[32:35], v[100:103], v[196:199]
    s_cmp_eq_u32 s56, 0x10000
    v_mfma_f32_16x16x32_bf16 v[200:203], v[32:35], v[104:107], v[200:203]
    s_cselect_b32 s58, 0xffff4000, s63
    v_mfma_f32_16x16x32_bf16 v[200:203], v[36:39], v[120:123], v[200:203]
    s_and_b32 s56, s56, 0xffff
    v_mfma_f32_16x16x32_bf16 v[204:207], v[36:39], v[124:127], v[204:207]
    v_mfma_f32_16x16x32_bf16 v[204:207], v[32:35], v[108:111], v[204:207]
    s_waitcnt lgkmcnt(6)
    v_mfma_f32_16x16x32_bf16 v[208:211], v[40:43], v[96:99], v[208:211]
    ds_read_b128 v[56:59], v20 offset:14336
    v_mfma_f32_16x16x32_bf16 v[208:211], v[44:47], v[112:115], v[208:211]
    v_add_u32 v22, s58, v22
    v_mfma_f32_16x16x32_bf16 v[212:215], v[44:47], v[116:119], v[212:215]
    ds_read_b128 v[60:63], v21 offset:14336
    v_mfma_f32_16x16x32_bf16 v[212:215], v[40:43], v[100:103], v[212:215]
    v_add_u32 v23, s58, v23
    v_mfma_f32_16x16x32_bf16 v[216:219], v[40:43], v[104:107], v[216:219]
    v_mfma_f32_16x16x32_bf16 v[216:219], v[44:47], v[120:123], v[216:219]
    v_add_u32 v24, s58, v24
    v_mfma_f32_16x16x32_bf16 v[220:223], v[44:47], v[124:127], v[220:223]
    v_mfma_f32_16x16x32_bf16 v[220:223], v[40:43], v[108:111], v[220:223]
    v_add_u32 v25, s58, v25
    s_waitcnt lgkmcnt(0)
    v_mfma_f32_16x16x32_bf16 v[224:227], v[48:51], v[96:99], v[224:227]
    v_mfma_f32_16x16x32_bf16 v[224:227], v[52:55], v[112:115], v[224:227]
    s_barrier
    v_mfma_f32_16x16x32_bf16 v[228:231], v[52:55], v[116:119], v[228:231]
    ds_read_b128 v[32:35], v16 offset:0
    v_mfma_f32_16x16x32_bf16 v[228:231], v[48:51], v[100:103], v[228:231]
    ds_read_b128 v[36:39], v16 offset:2048
    v_mfma_f32_16x16x32_bf16 v[232:235], v[48:51], v[104:107], v[232:235]
    s_sub_u32 s60, s54, s55
    v_mfma_f32_16x16x32_bf16 v[232:235], v[52:55], v[120:123], v[232:235]
    s_mov_b32 s55, s54
    v_mfma_f32_16x16x32_bf16 v[236:239], v[52:55], v[124:127], v[236:239]
    s_mov_b32 s54, s59
    v_mfma_f32_16x16x32_bf16 v[236:239], v[48:51], v[108:111], v[236:239]
    v_mfma_f32_16x16x32_bf16 v[240:243], v[56:59], v[96:99], v[240:243]
    ds_read_b128 v[40:43], v16 offset:4096
    v_mfma_f32_16x16x32_bf16 v[240:243], v[60:63], v[112:115], v[240:243]
    v_add_u32 v20, s60, v20
    v_mfma_f32_16x16x32_bf16 v[244:247], v[60:63], v[116:119], v[244:247]
    v_mfma_f32_16x16x32_bf16 v[244:247], v[56:59], v[100:103], v[244:247]
    v_add_u32 v21, s60, v21
    v_mfma_f32_16x16x32_bf16 v[248:251], v[56:59], v[104:107], v[248:251]
    v_mfma_f32_16x16x32_bf16 v[248:251], v[60:63], v[120:123], v[248:251]
    v_mfma_f32_16x16x32_bf16 v[252:255], v[60:63], v[124:127], v[252:255]
    v_mfma_f32_16x16x32_bf16 v[252:255], v[56:59], v[108:111], v[252:255]
    s_branch L_cloop
L_clast:
    s_setprio 3
    s_waitcnt lgkmcnt(1)
    v_mfma_f32_16x16x32_bf16 v[128:131], v[48:51], v[96:99], v[128:131]
    v_mfma_f32_16x16x32_bf16 v[128:131], v[52:55], v[112:115], v[128:131]
    ds_read_b128 v[32:35], v16 offset:6144
    v_mfma_f32_16x16x32_bf16 v[132:135], v[52:55], v[116:119], v[132:135]
    ds_read_b128 v[36:39], v16 offset:8192
    v_mfma_f32_16x16x32_bf16 v[132:135], v[48:51], v[100:103], v[132:135]
    ds_read_b64_tr_b16 v[64:65], v22 offset:0
    s_waitcnt lgkmcnt(3)
    v_mfma_f32_16x16x32_bf16 v[144:147], v[52:55], v[96:99], v[144:147]
    ds_read_b128 v[40:43], v16 offset:10240
    v_mfma_f32_16x16x32_bf16 v[144:147], v[56:59], v[112:115], v[144:147]
    ds_read_b64_tr_b16 v[66:67], v22 offset:1024
    v_mfma_f32_16x16x32_bf16 v[148:151], v[56:59], v[116:119], v[148:151]
    ds_read_b64_tr_b16 v[80:81], v22 offset:8192
    v_mfma_f32_16x16x32_bf16 v[148:151], v[52:55], v[100:103], v[148:151]
    s_waitcnt lgkmcnt(5)
    v_mfma_f32_16x16x32_bf16 v[160:163], v[56:59], v[96:99], v[160:163]
    ds_read_b128 v[44:47], v16 offset:12288
    v_mfma_f32_16x16x32_bf16 v[160:163], v[32:35], v[112:115], v[160:163]
    ds_read_b64_tr_b16 v[82:83], v22 offset:9216
    v_mfma_f32_16x16x32_bf16 v[164:167], v[32:35], v[116:119], v[164:167]
    ds_read_b64_tr_b16 v[68:69], v23 offset:0
    v_mfma_f32_16x16x32_bf16 v[164:167], v[56:59], v[100:103], v[164:167]
    s_waitcnt lgkmcnt(7)
    v_mfma_f32_16x16x32_bf16 v[176:179], v[32:35], v[96:99], v[176:179]
    ds_read_b128 v[60:63], v16 offset:14336
    v_mfma_f32_16x16x32_bf16 v[176:179], v[36:39], v[112:115], v[176:179]
    ds_read_b64_tr_b16 v[70:71], v23 offset:1024
    v_mfma_f32_16x16x32_bf16 v[180:183], v[36:39], v[116:119], v[180:183]
    ds_read_b64_tr_b16 v[84:85], v23 offset:8192
    v_mfma_f32_16x16x32_bf16 v[180:183], v[32:35], v[100:103], v[180:183]
    s_waitcnt lgkmcnt(8)
    v_mfma_f32_16x16x32_bf16 v[192:195], v[36:39], v[96:99], v[192:195]
    ds_read_b128 v[48:51], v18
    v_mfma_f32_16x16x32_bf16 v[192:195], v[40:43], v[112:115], v[192:195]
    ds_read_b64_tr_b16 v[86:87], v23 offset:9216
    v_mfma_f32_16x16x32_bf16 v[196:199], v[40:43], v[116:119], v[196:199]
    ds_read_b64_tr_b16 v[72:73], v24 offset:0
    v_mfma_f32_16x16x32_bf16 v[196:199], v[36:39], v[100:103], v[196:199]
    s_waitcnt lgkmcnt(8)
    v_mfma_f32_16x16x32_bf16 v[208:211], v[40:43], v[96:99], v[208:211]
    ds_read_b128 v[52:55], v17 offset:0
    v_mfma_f32_16x16x32_bf16 v[208:211], v[44:47], v[112:115], v[208:211]
    ds_read_b128 v[56:59], v17 offset:2048
    v_mfma_f32_16x16x32_bf16 v[212:215], v[44:47], v[116:119], v[212:215]
    ds_read_b64_tr_b16 v[74:75], v24 offset:1024
    v_mfma_f32_16x16x32_bf16 v[212:215], v[40:43], v[100:103], v[212:215]
    s_waitcnt lgkmcnt(8)
    v_mfma_f32_16x16x32_bf16 v[224:227], v[44:47], v[96:99], v[224:227]
    ds_read_b128 v[32:35], v17 offset:4096
    v_mfma_f32_16x16x32_bf16 v[224:227], v[60:63], v[112:115], v[224:227]
    ds_read_b64_tr_b16 v[88:89], v24 offset:8192
    v_mfma_f32_16x16x32_bf16 v[228:231], v[60:63], v[116:119], v[228:231]
    ds_read_b64_tr_b16 v[90:91], v24 offset:9216
    v_mfma_f32_16x16x32_bf16 v[228:231], v[44:47], v[100:103], v[228:231]
    s_waitcnt lgkmcnt(8)
    v_mfma_f32_16x16x32_bf16 v[240:243], v[60:63], v[96:99], v[240:243]
    v_mfma_f32_16x16x32_bf16 v[240:243], v[48:51], v[112:115], v[240:243]
    s_barrier
    v_mfma_f32_16x16x32_bf16 v[244:247], v[48:51], v[116:119], v[244:247]
    ds_read_b128 v[36:39], v17 offset:6144
    ds_read_b64_tr_b16 v[76:77], v25 offset:0
    ds_read_b64_tr_b16 v[78:79], v25 offset:1024
    v_mfma_f32_16x16x32_bf16 v[244:247], v[60:63], v[100:103], v[244:247]
    s_waitcnt lgkmcnt(7)
    v_mfma_f32_16x16x32_bf16 v[128:131], v[52:55], v[64:67], v[128:131]
    v_mfma_f32_16x16x32_bf16 v[128:131], v[56:59], v[80:83], v[128:131]
    ds_read_b128 v[40:43], v17 offset:8192
    v_mfma_f32_16x16x32_bf16 v[132:135], v[56:59], v[84:87], v[132:135]
    ds_read_b64_tr_b16 v[96:97], v22 offset:16384
    v_mfma_f32_16x16x32_bf16 v[132:135], v[52:55], v[68:71], v[132:135]
    ds_read_b64_tr_b16 v[98:99], v22 offset:17408
    s_waitcnt lgkmcnt(8)
    v_mfma_f32_16x16x32_bf16 v[144:147], v[56:59], v[64:67], v[144:147]
    ds_read_b128 v[44:47], v17 offset:10240
    v_mfma_f32_16x16x32_bf16 v[144:147], v[32:35], v[80:83], v[144:147]
    ds_read_b64_tr_b16 v[112:113], v22 offset:24576
    v_mfma_f32_16x16x32_bf16 v[148:151], v[32:35], v[84:87], v[148:151]
    ds_read_b64_tr_b16 v[114:115], v22 offset:25600
    v_mfma_f32_16x16x32_bf16 v[148:151], v[56:59], v[68:71], v[148:151]
    s_waitcnt lgkmcnt(8)
    v_mfma_f32_16x16x32_bf16 v[160:163], v[32:35], v[64:67], v[160:163]
    ds_read_b128 v[60:63], v17 offset:12288
    v_mfma_f32_16x16x32_bf16 v[160:163], v[36:39], v[80:83], v[160:163]
    ds_read_b64_tr_b16 v[100:101], v23 offset:16384
    v_mfma_f32_16x16x32_bf16 v[164:167], v[36:39], v[84:87], v[164:167]
    ds_read_b64_tr_b16 v[102:103], v23 offset:17408
    v_mfma_f32_16x16x32_bf16 v[164:167], v[32:35], v[68:71], v[164:167]
    s_waitcnt lgkmcnt(8)
    v_mfma_f32_16x16x32_bf16 v[176:179], v[36:39], v[64:67], v[176:179]
    ds_read_b128 v[48:51], v17 offset:14336
    v_mfma_f32_16x16x32_bf16 v[176:179], v[40:43], v[80:83], v[176:179]
    ds_read_b64_tr_b16 v[116:117], v23 offset:24576
    v_mfma_f32_16x16x32_bf16 v[180:183], v[40:43], v[84:87], v[180:183]
    ds_read_b64_tr_b16 v[118:119], v23 offset:25600
    v_mfma_f32_16x16x32_bf16 v[180:183], v[36:39], v[68:71], v[180:183]
    s_waitcnt lgkmcnt(8)
    v_mfma_f32_16x16x32_bf16 v[192:195], v[40:43], v[64:67], v[192:195]
    ds_read_b128 v[52:55], v19
    v_mfma_f32_16x16x32_bf16 v[192:195], v[44:47], v[80:83], v[192:195]
    ds_read_b64_tr_b16 v[92:93], v25 offset:8192
    v_mfma_f32_16x16x32_bf16 v[196:199], v[44:47], v[84:87], v[196:199]
    ds_read_b64_tr_b16 v[94:95], v25 offset:9216
    v_mfma_f32_16x16x32_bf16 v[196:199], v[40:43], v[68:71], v[196:199]
    s_waitcnt lgkmcnt(8)
    v_mfma_f32_16x16x32_bf16 v[208:211], v[44:47], v[64:67], v[208:211]
    v_mfma_f32_16x16x32_bf16 v[208:211], v[60:63], v[80:83], v[208:211]
    s_barrier
    v_mfma_f32_16x16x32_bf16 v[212:215], v[60:63], v[84:87], v[212:215]
    ds_read_b128 v[56:59], v20 offset:0
    ds_read_b128 v[32:35], v21 offset:0
    v_mfma_f32_16x16x32_bf16 v[212:215], v[44:47], v[68:71], v[212:215]
    s_waitcnt lgkmcnt(7)
    v_mfma_f32_16x16x32_bf16 v[224:227], v[60:63], v[64:67], v[224:227]
    ds_read_b128 v[36:39], v20 offset:2048
    v_mfma_f32_16x16x32_bf16 v[224:227], v[48:51], v[80:83], v[224:227]
    ds_read_b128 v[40:43], v21 offset:2048
    v_mfma_f32_16x16x32_bf16 v[228:231], v[48:51], v[84:87], v[228:231]
    v_mfma_f32_16x16x32_bf16 v[228:231], v[60:63], v[68:71], v[228:231]
    s_waitcnt lgkmcnt(6)
    v_mfma_f32_16x16x32_bf16 v[240:243], v[48:51], v[64:67], v[240:243]
    ds_read_b128 v[44:47], v20 offset:4096
    v_mfma_f32_16x16x32_bf16 v[240:243], v[52:55], v[80:83], v[240:243]
    ds_read_b128 v[60:63], v21 offset:4096
    v_mfma_f32_16x16x32_bf16 v[244:247], v[52:55], v[84:87], v[244:247]
    v_mfma_f32_16x16x32_bf16 v[244:247], v[48:51], v[68:71], v[244:247]
    s_waitcnt lgkmcnt(4)
    v_mfma_f32_16x16x32_bf16 v[128:131], v[56:59], v[96:99], v[128:131]
    v_mfma_f32_16x16x32_bf16 v[128:131], v[32:35], v[112:115], v[128:131]
    ds_read_b128 v[48:51], v20 offset:6144
    ds_read_b128 v[52:55], v21 offset:6144
    v_mfma_f32_16x16x32_bf16 v[132:135], v[32:35], v[116:119], v[132:135]
    ds_read_b64_tr_b16 v[64:65], v24 offset:16384
    ds_read_b64_tr_b16 v[66:67], v24 offset:17408
    v_mfma_f32_16x16x32_bf16 v[132:135], v[56:59], v[100:103], v[132:135]
    s_waitcnt lgkmcnt(6)
    v_mfma_f32_16x16x32_bf16 v[144:147], v[36:39], v[96:99], v[144:147]
    ds_read_b128 v[56:59], v20 offset:8192
    v_mfma_f32_16x16x32_bf16 v[144:147], v[40:43], v[112:115], v[144:147]
    ds_read_b128 v[32:35], v21 offset:8192
    v_mfma_f32_16x16x32_bf16 v[148:151], v[40:43], v[116:119], v[148:151]
    ds_read_b64_tr_b16 v[80:81], v24 offset:24576
    v_mfma_f32_16x16x32_bf16 v[148:151], v[36:39], v[100:103], v[148:151]
    ds_read_b64_tr_b16 v[82:83], v24 offset:25600
    s_waitcnt lgkmcnt(8)
    v_mfma_f32_16x16x32_bf16 v[160:163], v[44:47], v[96:99], v[160:163]
    ds_read_b128 v[36:39], v20 offset:10240
    v_mfma_f32_16x16x32_bf16 v[160:163], v[60:63], v[112:115], v[160:163]
    ds_read_b128 v[40:43], v21 offset:10240
    v_mfma_f32_16x16x32_bf16 v[164:167], v[60:63], v[116:119], v[164:167]
    ds_read_b64_tr_b16 v[68:69], v25 offset:16384
    v_mfma_f32_16x16x32_bf16 v[164:167], v[44:47], v[100:103], v[164:167]
    ds_read_b64_tr_b16 v[70:71], v25 offset:17408
    s_waitcnt lgkmcnt(10)
    v_mfma_f32_16x16x32_bf16 v[176:179], v[48:51], v[96:99], v[176:179]
    ds_read_b128 v[44:47], v20 offset:12288
    v_mfma_f32_16x16x32_bf16 v[176:179], v[52:55], v[112:115], v[176:179]
    ds_read_b128 v[60:63], v21 offset:12288
    v_mfma_f32_16x16x32_bf16 v[180:183], v[52:55], v[116:119], v[180:183]
    ds_read_b64_tr_b16 v[84:85], v25 offset:24576
    v_mfma_f32_16x16x32_bf16 v[180:183], v[48:51], v[100:103], v[180:183]
    ds_read_b64_tr_b16 v[86:87], v25 offset:25600
    s_waitcnt lgkmcnt(10)
    v_mfma_f32_16x16x32_bf16 v[192:195], v[56:59], v[96:99], v[192:195]
    ds_read_b128 v[48:51], v20 offset:14336
    v_mfma_f32_16x16x32_bf16 v[192:195], v[32:35], v[112:115], v[192:195]
    ds_read_b128 v[52:55], v21 offset:14336
    v_mfma_f32_16x16x32_bf16 v[196:199], v[32:35], v[116:119], v[196:199]
    v_mfma_f32_16x16x32_bf16 v[196:199], v[56:59], v[100:103], v[196:199]
    s_waitcnt lgkmcnt(2)
    v_mfma_f32_16x16x32_bf16 v[208:211], v[36:39], v[96:99], v[208:211]
    v_mfma_f32_16x16x32_bf16 v[208:211], v[40:43], v[112:115], v[208:211]
    s_barrier
    v_mfma_f32_16x16x32_bf16 v[212:215], v[40:43], v[116:119], v[212:215]
    ds_read_b128 v[56:59], v16 offset:0
    ds_read_b128 v[32:35], v16 offset:2048
    v_mfma_f32_16x16x32_bf16 v[212:215], v[36:39], v[100:103], v[212:215]
    v_mfma_f32_16x16x32_bf16 v[224:227], v[44:47], v[96:99], v[224:227]
    ds_read_b128 v[36:39], v16 offset:4096
    v_mfma_f32_16x16x32_bf16 v[224:227], v[60:63], v[112:115], v[224:227]
    v_mfma_f32_16x16x32_bf16 v[228:231], v[60:63], v[116:119], v[228:231]
    v_mfma_f32_16x16x32_bf16 v[228:231], v[44:47], v[100:103], v[228:231]
    s_waitcnt lgkmcnt(3)
    v_mfma_f32_16x16x32_bf16 v[240:243], v[48:51], v[96:99], v[240:243]
    ds_read_b128 v[40:43], v16 offset:6144
    v_mfma_f32_16x16x32_bf16 v[240:243], v[52:55], v[112:115], v[240:243]
    v_mfma_f32_16x16x32_bf16 v[244:247], v[52:55], v[116:119], v[244:247]
    v_mfma_f32_16x16x32_bf16 v[244:247], v[48:51], v[100:103], v[244:247]
    s_nop 4
    v_cndmask_b32 v147, 0, v147, s[64:65]
    v_cndmask_b32 v163, 0, v163, s[66:67]
    v_cndmask_b32 v151, 0, v151, s[64:65]
    v_cndmask_b32 v167, 0, v167, s[66:67]
    v_pk_mul_f32 v[98:99], v[128:129], v[128:129]
    v_pk_mul_f32 v[102:103], v[132:133], v[132:133]
    v_pk_fma_f32 v[98:99], v[130:131], v[130:131], v[98:99]
    v_pk_add_f32 v[96:97], v[128:129], v[130:131]
    v_pk_fma_f32 v[102:103], v[134:135], v[134:135], v[102:103]
    v_pk_add_f32 v[100:101], v[132:133], v[134:135]
    v_pk_fma_f32 v[98:99], v[144:145], v[144:145], v[98:99]
    v_pk_add_f32 v[96:97], v[96:97], v[144:145]
    v_pk_fma_f32 v[102:103], v[148:149], v[148:149], v[102:103]
    v_pk_add_f32 v[100:101], v[100:101], v[148:149]
    v_pk_fma_f32 v[98:99], v[146:147], v[146:147], v[98:99]
    v_pk_add_f32 v[96:97], v[96:97], v[146:147]
    v_pk_fma_f32 v[102:103], v[150:151], v[150:151], v[102:103]
    v_pk_add_f32 v[100:101], v[100:101], v[150:151]
    v_pk_fma_f32 v[98:99], v[160:161], v[160:161], v[98:99]
    v_pk_add_f32 v[96:97], v[96:97], v[160:161]
    v_pk_fma_f32 v[102:103], v[164:165], v[164:165], v[102:103]
    v_pk_add_f32 v[100:101], v[100:101], v[164:165]
    v_pk_fma_f32 v[98:99], v[162:163], v[162:163], v[98:99]
    v_pk_add_f32 v[96:97], v[96:97], v[162:163]
    v_pk_fma_f32 v[102:103], v[166:167], v[166:167], v[102:103]
    v_pk_add_f32 v[100:101], v[100:101], v[166:167]
    v_pk_fma_f32 v[98:99], v[176:177], v[176:177], v[98:99]
    v_pk_add_f32 v[96:97], v[96:97], v[176:177]
    v_pk_fma_f32 v[102:103], v[180:181], v[180:181], v[102:103]
    v_pk_add_f32 v[100:101], v[100:101], v[180:181]
    v_pk_fma_f32 v[98:99], v[178:179], v[178:179], v[98:99]
    v_pk_add_f32 v[96:97], v[96:97], v[178:179]
    v_pk_fma_f32 v[102:103], v[182:183], v[182:183], v[102:103]
    v_pk_add_f32 v[100:101], v[100:101], v[182:183]
    v_pk_fma_f32 v[98:99], v[192:193], v[192:193], v[98:99]
    v_pk_add_f32 v[96:97], v[96:97], v[192:193]
    v_pk_fma_f32 v[102:103], v[196:197], v[196:197], v[102:103]
    v_pk_add_f32 v[100:101], v[100:101], v[196:197]
    v_pk_fma_f32 v[98:99], v[194:195], v[194:195], v[98:99]
    v_pk_add_f32 v[96:97], v[96:97], v[194:195]
    v_pk_fma_f32 v[102:103], v[198:199], v[198:199], v[102:103]
    v_pk_add_f32 v[100:101], v[100:101], v[198:199]
    v_pk_fma_f32 v[98:99], v[208:209], v[208:209], v[98:99]
    v_pk_add_f32 v[96:97], v[96:97], v[208:209]
    v_pk_fma_f32 v[102:103], v[212:213], v[212:213], v[102:103]
    v_pk_add_f32 v[100:101], v[100:101], v[212:213]
    v_pk_fma_f32 v[98:99], v[210:211], v[210:211], v[98:99]
    v_pk_add_f32 v[96:97], v[96:97], v[210:211]
    v_pk_fma_f32 v[102:103], v[214:215], v[214:215], v[102:103]
    v_pk_add_f32 v[100:101], v[100:101], v[214:215]
    v_pk_fma_f32 v[98:99], v[224:225], v[224:225], v[98:99]
    v_pk_add_f32 v[96:97], v[96:97], v[224:225]
    v_pk_fma_f32 v[102:103], v[228:229], v[228:229], v[102:103]
    v_pk_add_f32 v[100:101], v[100:101], v[228:229]
    v_pk_fma_f32 v[98:99], v[226:227], v[226:227], v[98:99]
    v_pk_add_f32 v[96:97], v[96:97], v[226:227]
    v_pk_fma_f32 v[102:103], v[230:231], v[230:231], v[102:103]
    v_pk_add_f32 v[100:101], v[100:101], v[230:231]
    v_pk_fma_f32 v[98:99], v[240:241], v[240:241], v[98:99]
    v_pk_add_f32 v[96:97], v[96:97], v[240:241]
    v_pk_fma_f32 v[102:103], v[244:245], v[244:245], v[102:103]
    v_pk_add_f32 v[100:101], v[100:101], v[244:245]
    v_pk_fma_f32 v[98:99], v[242:243], v[242:243], v[98:99]
    v_pk_add_f32 v[96:97], v[96:97], v[242:243]
    v_pk_fma_f32 v[102:103], v[246:247], v[246:247], v[102:103]
    v_pk_add_f32 v[100:101], v[100:101], v[246:247]
    v_add_f32 v96, v96, v97
    v_add_f32 v100, v100, v101
    v_add_f32 v97, v98, v99
    v_add_f32 v101, v102, v103
    s_nop 0
    v_permlane32_swap_b32 v96, v100
    v_permlane32_swap_b32 v97, v101
    s_nop 0
    v_add_f32 v96, v96, v100
    v_add_f32 v97, v97, v101
    v_mov_b32 v100, v96
    v_mov_b32 v101, v97
    s_nop 1
    v_permlane16_swap_b32 v96, v100
    v_permlane16_swap_b32 v97, v101
    s_nop 0
    v_add_f32 v96, v96, v100
    v_add_f32 v97, v97, v101
    ds_write_b64 v27, v[96:97] offset:32768
    s_waitcnt lgkmcnt(3)
    v_mfma_f32_16x16x32_bf16 v[136:139], v[56:59], v[104:107], v[136:139]
    v_mfma_f32_16x16x32_bf16 v[136:139], v[32:35], v[120:123], v[136:139]
    ds_read_b128 v[44:47], v16 offset:8192
    v_xor_b32 v4, 0, v26
    v_mfma_f32_16x16x32_bf16 v[140:143], v[32:35], v[124:127], v[140:143]
    ds_write2st64_b32 v4, v128, v129 offset0:0 offset1:8
    v_mfma_f32_16x16x32_bf16 v[140:143], v[56:59], v[108:111], v[140:143]
    s_waitcnt lgkmcnt(4)
    v_mfma_f32_16x16x32_bf16 v[152:155], v[32:35], v[104:107], v[152:155]
    ds_read_b128 v[60:63], v16 offset:10240
    v_mfma_f32_16x16x32_bf16 v[152:155], v[36:39], v[120:123], v[152:155]
    ds_write2st64_b32 v4, v130, v131 offset0:16 offset1:24
    v_mfma_f32_16x16x32_bf16 v[156:159], v[36:39], v[124:127], v[156:159]
    ds_write2st64_b32 v4, v144, v145 offset0:1 offset1:9
    v_mfma_f32_16x16x32_bf16 v[156:159], v[32:35], v[108:111], v[156:159]
    s_waitcnt lgkmcnt(6)
    v_mfma_f32_16x16x32_bf16 v[168:171], v[36:39], v[104:107], v[168:171]
    ds_read_b128 v[48:51], v16 offset:12288
    v_mfma_f32_16x16x32_bf16 v[168:171], v[40:43], v[120:123], v[168:171]
    ds_write2st64_b32 v4, v146, v147 offset0:17 offset1:25
    v_mfma_f32_16x16x32_bf16 v[172:175], v[40:43], v[124:127], v[172:175]
    ds_write2st64_b32 v4, v192, v193 offset0:4 offset1:12
    v_mfma_f32_16x16x32_bf16 v[172:175], v[36:39], v[108:111], v[172:175]
    s_waitcnt lgkmcnt(7)
    v_mfma_f32_16x16x32_bf16 v[184:187], v[40:43], v[104:107], v[184:187]
    ds_read_b128 v[52:55], v16 offset:14336
    v_mfma_f32_16x16x32_bf16 v[184:187], v[44:47], v[120:123], v[184:187]
    ds_write2st64_b32 v4, v194, v195 offset0:20 offset1:28
    v_mfma_f32_16x16x32_bf16 v[188:191], v[44:47], v[124:127], v[188:191]
    ds_write2st64_b32 v4, v208, v209 offset0:5 offset1:13
    v_mfma_f32_16x16x32_bf16 v[188:191], v[40:43], v[108:111], v[188:191]
    s_waitcnt lgkmcnt(8)
    v_mfma_f32_16x16x32_bf16 v[200:203], v[44:47], v[104:107], v[200:203]
    ds_read_b128 v[112:115], v18
    v_mfma_f32_16x16x32_bf16 v[200:203], v[60:63], v[120:123], v[200:203]
    ds_write2st64_b32 v4, v210, v211 offset0:21 offset1:29
    v_mfma_f32_16x16x32_bf16 v[204:207], v[60:63], v[124:127], v[204:207]
    v_mfma_f32_16x16x32_bf16 v[204:207], v[44:47], v[108:111], v[204:207]
    v_xor_b32 v5, 128, v26
    s_waitcnt lgkmcnt(7)
    v_mfma_f32_16x16x32_bf16 v[216:219], v[60:63], v[104:107], v[216:219]
    ds_read_b128 v[116:119], v17 offset:0
    v_mfma_f32_16x16x32_bf16 v[216:219], v[48:51], v[120:123], v[216:219]
    ds_read_b128 v[56:59], v17 offset:2048
    v_mfma_f32_16x16x32_bf16 v[220:223], v[48:51], v[124:127], v[220:223]
    ds_write2st64_b32 v5, v160, v161 offset0:2 offset1:10
    v_mfma_f32_16x16x32_bf16 v[220:223], v[60:63], v[108:111], v[220:223]
    s_waitcnt lgkmcnt(7)
    v_mfma_f32_16x16x32_bf16 v[232:235], v[48:51], v[104:107], v[232:235]
    ds_read_b128 v[32:35], v17 offset:4096
    v_mfma_f32_16x16x32_bf16 v[232:235], v[52:55], v[120:123], v[232:235]
    ds_write2st64_b32 v5, v162, v163 offset0:18 offset1:26
    v_mfma_f32_16x16x32_bf16 v[236:239], v[52:55], v[124:127], v[236:239]
    ds_write2st64_b32 v5, v176, v177 offset0:3 offset1:11
    v_mfma_f32_16x16x32_bf16 v[236:239], v[48:51], v[108:111], v[236:239]
    s_waitcnt lgkmcnt(7)
    v_mfma_f32_16x16x32_bf16 v[248:251], v[52:55], v[104:107], v[248:251]
    ds_read_b128 v[36:39], v17 offset:6144
    v_mfma_f32_16x16x32_bf16 v[248:251], v[112:115], v[120:123], v[248:251]
    ds_write2st64_b32 v5, v178, v179 offset0:19 offset1:27
    v_mfma_f32_16x16x32_bf16 v[252:255], v[112:115], v[124:127], v[252:255]
    ds_write2st64_b32 v5, v224, v225 offset0:6 offset1:14
    v_mfma_f32_16x16x32_bf16 v[252:255], v[52:55], v[108:111], v[252:255]
    s_waitcnt lgkmcnt(7)
    v_mfma_f32_16x16x32_bf16 v[136:139], v[116:119], v[72:75], v[136:139]
    v_mfma_f32_16x16x32_bf16 v[136:139], v[56:59], v[88:91], v[136:139]
    ds_read_b128 v[40:43], v17 offset:8192
    v_mfma_f32_16x16x32_bf16 v[140:143], v[56:59], v[92:95], v[140:143]
    ds_write2st64_b32 v5, v226, v227 offset0:22 offset1:30
    v_mfma_f32_16x16x32_bf16 v[140:143], v[116:119], v[76:79], v[140:143]
    ds_write2st64_b32 v5, v240, v241 offset0:7 offset1:15
    s_waitcnt lgkmcnt(8)
    v_mfma_f32_16x16x32_bf16 v[152:155], v[56:59], v[72:75], v[152:155]
    ds_read_b128 v[44:47], v17 offset:10240
    v_mfma_f32_16x16x32_bf16 v[152:155], v[32:35], v[88:91], v[152:155]
    ds_write2st64_b32 v5, v242, v243 offset0:23 offset1:31
    v_mfma_f32_16x16x32_bf16 v[156:159], v[32:35], v[92:95], v[156:159]
    v_mfma_f32_16x16x32_bf16 v[156:159], v[56:59], v[76:79], v[156:159]
    v_xor_b32 v4, 32, v26
    s_waitcnt lgkmcnt(7)
    v_mfma_f32_16x16x32_bf16 v[168:171], v[32:35], v[72:75], v[168:171]
    ds_read_b128 v[60:63], v17 offset:12288
    v_mfma_f32_16x16x32_bf16 v[168:171], v[36:39], v[88:91], v[168:171]
    ds_write2st64_b32 v4, v132, v133 offset0:0 offset1:8
    v_mfma_f32_16x16x32_bf16 v[172:175], v[36:39], v[92:95], v[172:175]
    ds_write2st64_b32 v4, v134, v135 offset0:16 offset1:24
    v_mfma_f32_16x16x32_bf16 v[172:175], v[32:35], v[76:79], v[172:175]
    s_waitcnt lgkmcnt(7)
    v_mfma_f32_16x16x32_bf16 v[184:187], v[36:39], v[72:75], v[184:187]
    ds_read_b128 v[48:51], v17 offset:14336
    v_mfma_f32_16x16x32_bf16 v[184:187], v[40:43], v[88:91], v[184:187]
    ds_write2st64_b32 v4, v148, v149 offset0:1 offset1:9
    v_mfma_f32_16x16x32_bf16 v[188:191], v[40:43], v[92:95], v[188:191]
    ds_write2st64_b32 v4, v150, v151 offset0:17 offset1:25
    v_mfma_f32_16x16x32_bf16 v[188:191], v[36:39], v[76:79], v[188:191]
    s_waitcnt lgkmcnt(7)
    v_mfma_f32_16x16x32_bf16 v[200:203], v[40:43], v[72:75], v[200:203]
    ds_read_b128 v[52:55], v19
    v_mfma_f32_16x16x32_bf16 v[200:203], v[44:47], v[88:91], v[200:203]
    ds_write2st64_b32 v4, v196, v197 offset0:4 offset1:12
    v_mfma_f32_16x16x32_bf16 v[204:207], v[44:47], v[92:95], v[204:207]
    ds_write2st64_b32 v4, v198, v199 offset0:20 offset1:28
    v_mfma_f32_16x16x32_bf16 v[204:207], v[40:43], v[76:79], v[204:207]
    s_waitcnt lgkmcnt(8)
    v_mfma_f32_16x16x32_bf16 v[216:219], v[44:47], v[72:75], v[216:219]
    ds_read_b128 v[112:115], v20 offset:0
    v_mfma_f32_16x16x32_bf16 v[216:219], v[60:63], v[88:91], v[216:219]
    ds_read_b128 v[116:119], v21 offset:0
    v_mfma_f32_16x16x32_bf16 v[220:223], v[60:63], v[92:95], v[220:223]
    ds_write2st64_b32 v4, v212, v213 offset0:5 offset1:13
    v_mfma_f32_16x16x32_bf16 v[220:223], v[44:47], v[76:79], v[220:223]
    s_waitcnt lgkmcnt(8)
    v_mfma_f32_16x16x32_bf16 v[232:235], v[60:63], v[72:75], v[232:235]
    ds_read_b128 v[56:59], v20 offset:2048
    v_mfma_f32_16x16x32_bf16 v[232:235], v[48:51], v[88:91], v[232:235]
    ds_read_b128 v[32:35], v21 offset:2048
    v_mfma_f32_16x16x32_bf16 v[236:239], v[48:51], v[92:95], v[236:239]
    ds_write2st64_b32 v4, v214, v215 offset0:21 offset1:29
    v_mfma_f32_16x16x32_bf16 v[236:239], v[60:63], v[76:79], v[236:239]
    s_waitcnt lgkmcnt(8)
    v_mfma_f32_16x16x32_bf16 v[248:251], v[48:51], v[72:75], v[248:251]
    ds_read_b128 v[36:39], v20 offset:4096
    v_mfma_f32_16x16x32_bf16 v[248:251], v[52:55], v[88:91], v[248:251]
    ds_read_b128 v[40:43], v21 offset:4096
    v_mfma_f32_16x16x32_bf16 v[252:255], v[52:55], v[92:95], v[252:255]
    v_mfma_f32_16x16x32_bf16 v[252:255], v[48:51], v[76:79], v[252:255]
    v_xor_b32 v5, 160, v26
    s_waitcnt lgkmcnt(6)
    v_mfma_f32_16x16x32_bf16 v[136:139], v[112:115], v[64:67], v[136:139]
    v_mfma_f32_16x16x32_bf16 v[136:139], v[116:119], v[80:83], v[136:139]
    ds_read_b128 v[44:47], v20 offset:6144
    v_mfma_f32_16x16x32_bf16 v[140:143], v[116:119], v[84:87], v[140:143]
    ds_read_b128 v[60:63], v21 offset:6144
    v_mfma_f32_16x16x32_bf16 v[140:143], v[112:115], v[68:71], v[140:143]
    ds_write2st64_b32 v5, v164, v165 offset0:2 offset1:10
    s_waitcnt lgkmcnt(6)
    v_mfma_f32_16x16x32_bf16 v[152:155], v[56:59], v[64:67], v[152:155]
    ds_read_b128 v[48:51], v20 offset:8192
    v_mfma_f32_16x16x32_bf16 v[152:155], v[32:35], v[80:83], v[152:155]
    ds_read_b128 v[52:55], v21 offset:8192
    v_mfma_f32_16x16x32_bf16 v[156:159], v[32:35], v[84:87], v[156:159]
    ds_write2st64_b32 v5, v166, v167 offset0:18 offset1:26
    v_mfma_f32_16x16x32_bf16 v[156:159], v[56:59], v[68:71], v[156:159]
    s_waitcnt lgkmcnt(6)
    v_mfma_f32_16x16x32_bf16 v[168:171], v[36:39], v[64:67], v[168:171]
    ds_read_b128 v[112:115], v20 offset:10240
    v_mfma_f32_16x16x32_bf16 v[168:171], v[40:43], v[80:83], v[168:171]
    ds_read_b128 v[116:119], v21 offset:10240
    v_mfma_f32_16x16x32_bf16 v[172:175], v[40:43], v[84:87], v[172:175]
    ds_write2st64_b32 v5, v180, v181 offset0:3 offset1:11
    v_mfma_f32_16x16x32_bf16 v[172:175], v[36:39], v[68:71], v[172:175]
    s_waitcnt lgkmcnt(7)
    v_mfma_f32_16x16x32_bf16 v[184:187], v[44:47], v[64:67], v[184:187]
    ds_read_b128 v[56:59], v20 offset:12288
    v_mfma_f32_16x16x32_bf16 v[184:187], v[60:63], v[80:83], v[184:187]
    ds_read_b128 v[32:35], v21 offset:12288
    v_mfma_f32_16x16x32_bf16 v[188:191], v[60:63], v[84:87], v[188:191]
    ds_write2st64_b32 v5, v182, v183 offset0:19 offset1:27
    v_mfma_f32_16x16x32_bf16 v[188:191], v[44:47], v[68:71], v[188:191]
    s_waitcnt lgkmcnt(7)
    v_mfma_f32_16x16x32_bf16 v[200:203], v[48:51], v[64:67], v[200:203]
    ds_read_b128 v[36:39], v20 offset:14336
    v_mfma_f32_16x16x32_bf16 v[200:203], v[52:55], v[80:83], v[200:203]
    ds_read_b128 v[40:43], v21 offset:14336
    v_mfma_f32_16x16x32_bf16 v[204:207], v[52:55], v[84:87], v[204:207]
    ds_write2st64_b32 v5, v228, v229 offset0:6 offset1:14
    v_mfma_f32_16x16x32_bf16 v[204:207], v[48:51], v[68:71], v[204:207]
    s_waitcnt lgkmcnt(7)
    v_mfma_f32_16x16x32_bf16 v[216:219], v[112:115], v[64:67], v[216:219]
    ds_write2st64_b32 v5, v230, v231 offset0:22 offset1:30
    v_mfma_f32_16x16x32_bf16 v[216:219], v[116:119], v[80:83], v[216:219]
    ds_write2st64_b32 v5, v244, v245 offset0:7 offset1:15
    v_mfma_f32_16x16x32_bf16 v[220:223], v[116:119], v[84:87], v[220:223]
    ds_write2st64_b32 v5, v246, v247 offset0:23 offset1:31
    v_mfma_f32_16x16x32_bf16 v[220:223], v[112:115], v[68:71], v[220:223]
    s_waitcnt lgkmcnt(7)
    v_mfma_f32_16x16x32_bf16 v[232:235], v[56:59], v[64:67], v[232:235]
    ds_write_b32 v15, v13 offset:35856
    v_mfma_f32_16x16x32_bf16 v[232:235], v[32:35], v[80:83], v[232:235]
    v_mfma_f32_16x16x32_bf16 v[236:239], v[32:35], v[84:87], v[236:239]
    v_mfma_f32_16x16x32_bf16 v[236:239], v[56:59], v[68:71], v[236:239]
    s_waitcnt lgkmcnt(5)
    v_mfma_f32_16x16x32_bf16 v[248:251], v[36:39], v[64:67], v[248:251]
    v_mfma_f32_16x16x32_bf16 v[248:251], v[40:43], v[80:83], v[248:251]
    v_mfma_f32_16x16x32_bf16 v[252:255], v[40:43], v[84:87], v[252:255]
    v_mfma_f32_16x16x32_bf16 v[252:255], v[36:39], v[68:71], v[252:255]
    s_nop 7
    s_mov_b32 s59, 262144
    v_cndmask_b32 v155, 0, v155, s[64:65]
    v_cndmask_b32 v171, 0, v171, s[66:67]
    v_cndmask_b32 v159, 0, v159, s[64:65]
    v_cndmask_b32 v175, 0, v175, s[66:67]
    v_pk_mul_f32 v[98:99], v[136:137], v[136:137]
    v_pk_mul_f32 v[102:103], v[140:141], v[140:141]
    v_pk_fma_f32 v[98:99], v[138:139], v[138:139], v[98:99]
    v_pk_add_f32 v[96:97], v[136:137], v[138:139]
    v_pk_fma_f32 v[102:103], v[142:143], v[142:143], v[102:103]
    v_pk_add_f32 v[100:101], v[140:141], v[142:143]
    v_pk_fma_f32 v[98:99], v[152:153], v[152:153], v[98:99]
    v_pk_add_f32 v[96:97], v[96:97], v[152:153]
    v_pk_fma_f32 v[102:103], v[156:157], v[156:157], v[102:103]
    v_pk_add_f32 v[100:101], v[100:101], v[156:157]
    v_pk_fma_f32 v[98:99], v[154:155], v[154:155], v[98:99]
    v_pk_add_f32 v[96:97], v[96:97], v[154:155]
    v_pk_fma_f32 v[102:103], v[158:159], v[158:159], v[102:103]
    v_pk_add_f32 v[100:101], v[100:101], v[158:159]
    v_pk_fma_f32 v[98:99], v[168:169], v[168:169], v[98:99]
    v_pk_add_f32 v[96:97], v[96:97], v[168:169]
    v_pk_fma_f32 v[102:103], v[172:173], v[172:173], v[102:103]
    v_pk_add_f32 v[100:101], v[100:101], v[172:173]
    v_pk_fma_f32 v[98:99], v[170:171], v[170:171], v[98:99]
    v_pk_add_f32 v[96:97], v[96:97], v[170:171]
    v_pk_fma_f32 v[102:103], v[174:175], v[174:175], v[102:103]
    v_pk_add_f32 v[100:101], v[100:101], v[174:175]
    v_pk_fma_f32 v[98:99], v[184:185], v[184:185], v[98:99]
    v_pk_add_f32 v[96:97], v[96:97], v[184:185]
    v_pk_fma_f32 v[102:103], v[188:189], v[188:189], v[102:103]
    v_pk_add_f32 v[100:101], v[100:101], v[188:189]
    v_pk_fma_f32 v[98:99], v[186:187], v[186:187], v[98:99]
    v_pk_add_f32 v[96:97], v[96:97], v[186:187]
    v_pk_fma_f32 v[102:103], v[190:191], v[190:191], v[102:103]
    v_pk_add_f32 v[100:101], v[100:101], v[190:191]
    v_pk_fma_f32 v[98:99], v[200:201], v[200:201], v[98:99]
    v_pk_add_f32 v[96:97], v[96:97], v[200:201]
    v_pk_fma_f32 v[102:103], v[204:205], v[204:205], v[102:103]
    v_pk_add_f32 v[100:101], v[100:101], v[204:205]
    v_pk_fma_f32 v[98:99], v[202:203], v[202:203], v[98:99]
    v_pk_add_f32 v[96:97], v[96:97], v[202:203]
    v_pk_fma_f32 v[102:103], v[206:207], v[206:207], v[102:103]
    v_pk_add_f32 v[100:101], v[100:101], v[206:207]
    v_pk_fma_f32 v[98:99], v[216:217], v[216:217], v[98:99]
    v_pk_add_f32 v[96:97], v[96:97], v[216:217]
    v_pk_fma_f32 v[102:103], v[220:221], v[220:221], v[102:103]
    v_pk_add_f32 v[100:101], v[100:101], v[220:221]
    v_pk_fma_f32 v[98:99], v[218:219], v[218:219], v[98:99]
    v_pk_add_f32 v[96:97], v[96:97], v[218:219]
    v_pk_fma_f32 v[102:103], v[222:223], v[222:223], v[102:103]
    v_pk_add_f32 v[100:101], v[100:101], v[222:223]
    v_pk_fma_f32 v[98:99], v[232:233], v[232:233], v[98:99]
    v_pk_add_f32 v[96:97], v[96:97], v[232:233]
    v_pk_fma_f32 v[102:103], v[236:237], v[236:237], v[102:103]
    v_pk_add_f32 v[100:101], v[100:101], v[236:237]
    v_pk_fma_f32 v[98:99], v[234:235], v[234:235], v[98:99]
    v_pk_add_f32 v[96:97], v[96:97], v[234:235]
    v_pk_fma_f32 v[102:103], v[238:239], v[238:239], v[102:103]
    v_pk_add_f32 v[100:101], v[100:101], v[238:239]
    v_pk_fma_f32 v[98:99], v[248:249], v[248:249], v[98:99]
    v_pk_add_f32 v[96:97], v[96:97], v[248:249]
    v_pk_fma_f32 v[102:103], v[252:253], v[252:253], v[102:103]
    v_pk_add_f32 v[100:101], v[100:101], v[252:253]
    v_pk_fma_f32 v[98:99], v[250:251], v[250:251], v[98:99]
    v_pk_add_f32 v[96:97], v[96:97], v[250:251]
    v_pk_fma_f32 v[102:103], v[254:255], v[254:255], v[102:103]
    v_pk_add_f32 v[100:101], v[100:101], v[254:255]
    v_add_f32 v96, v96, v97
    v_add_f32 v100, v100, v101
    v_add_f32 v97, v98, v99
    v_add_f32 v101, v102, v103
    s_nop 0
    v_permlane32_swap_b32 v96, v100
    v_permlane32_swap_b32 v97, v101
    s_nop 0
    v_add_f32 v96, v96, v100
    v_add_f32 v97, v97, v101
    v_mov_b32 v100, v96
    v_mov_b32 v101, v97
    s_nop 1
    v_permlane16_swap_b32 v96, v100
    v_permlane16_swap_b32 v97, v101
    s_nop 0
    v_add_f32 v96, v96, v100
    v_add_f32 v97, v97, v101
    ds_write_b64 v27, v[96:97] offset:33792
L_cpart:
    ds_read_b128 v[32:35], v28 offset:33792
    s_waitcnt lgkmcnt(0)
    v_min_f32 v1, v33, v35
    v_cmp_gt_f32 vcc, 0, v1
    s_cbranch_vccz L_cpart_ok
    s_sub_u32 s59, s59, 1
    s_cmp_gt_i32 s59, 0
    s_cbranch_scc1 L_cpart
L_cpart_ok:
    v_mov_b32 v36, v32
    v_mov_b32 v37, v33
    v_mov_b32 v38, v34
    v_mov_b32 v39, v35
    v_permlane32_swap_b32 v32, v36
    v_permlane32_swap_b32 v33, v37
    v_permlane32_swap_b32 v34, v38
    v_permlane32_swap_b32 v35, v39
    v_add_f32 v32, v32, v36
    v_add_f32 v33, v33, v37
    v_add_f32 v34, v34, v38
    v_add_f32 v35, v35, v39
    s_mov_b64 exec, s[90:91]
    buffer_store_dwordx4 v[32:35], v29, s[20:23], 0 offen sc1
    s_mov_b64 exec, -1
    s_setprio 0
    v_add_u32 v26, s40, v26
    v_xor_b32 v4, 0, v26
    ds_write2st64_b32 v4, v136, v137 offset0:0 offset1:8
    ds_write2st64_b32 v4, v138, v139 offset0:16 offset1:24
    ds_write2st64_b32 v4, v152, v153 offset0:1 offset1:9
    ds_write2st64_b32 v4, v154, v155 offset0:17 offset1:25
    ds_write2st64_b32 v4, v200, v201 offset0:4 offset1:12
    ds_write2st64_b32 v4, v202, v203 offset0:20 offset1:28
    ds_write2st64_b32 v4, v216, v217 offset0:5 offset1:13
    ds_write2st64_b32 v4, v218, v219 offset0:21 offset1:29
    v_xor_b32 v5, 128, v26
    ds_write2st64_b32 v5, v168, v169 offset0:2 offset1:10
    ds_write2st64_b32 v5, v170, v171 offset0:18 offset1:26
    ds_write2st64_b32 v5, v184, v185 offset0:3 offset1:11
    ds_write2st64_b32 v5, v186, v187 offset0:19 offset1:27
    ds_write2st64_b32 v5, v232, v233 offset0:6 offset1:14
    ds_write2st64_b32 v5, v234, v235 offset0:22 offset1:30
    ds_write2st64_b32 v5, v248, v249 offset0:7 offset1:15
    ds_write2st64_b32 v5, v250, v251 offset0:23 offset1:31
    v_xor_b32 v4, 32, v26
    ds_write2st64_b32 v4, v140, v141 offset0:0 offset1:8
    ds_write2st64_b32 v4, v142, v143 offset0:16 offset1:24
    ds_write2st64_b32 v4, v156, v157 offset0:1 offset1:9
    ds_write2st64_b32 v4, v158, v159 offset0:17 offset1:25
    ds_write2st64_b32 v4, v204, v205 offset0:4 offset1:12
    ds_write2st64_b32 v4, v206, v207 offset0:20 offset1:28
    ds_write2st64_b32 v4, v220, v221 offset0:5 offset1:13
    ds_write2st64_b32 v4, v222, v223 offset0:21 offset1:29
    v_xor_b32 v5, 160, v26
    ds_write2st64_b32 v5, v172, v173 offset0:2 offset1:10
    ds_write2st64_b32 v5, v174, v175 offset0:18 offset1:26
    ds_write2st64_b32 v5, v188, v189 offset0:3 offset1:11
    ds_write2st64_b32 v5, v190, v191 offset0:19 offset1:27
    ds_write2st64_b32 v5, v236, v237 offset0:6 offset1:14
    ds_write2st64_b32 v5, v238, v239 offset0:22 offset1:30
    ds_write2st64_b32 v5, v252, v253 offset0:7 offset1:15
    ds_write2st64_b32 v5, v254, v255 offset0:23 offset1:31
    ds_write_b32 v15, v13 offset:35872
    s_branch L_imgwait
L_end:
    s_endpgm
.section .rodata,"a"
.p2align 6
.amdhsa_kernel standalone__self_sup_conv_stem_wavlm__speech_kernel
  .amdhsa_next_free_vgpr 256
  .amdhsa_next_free_sgpr 102
  .amdhsa_accum_offset 256
  .amdhsa_group_segment_fixed_size 0
  .amdhsa_kernarg_size 56
  .amdhsa_user_sgpr_count 2
  .amdhsa_user_sgpr_kernarg_segment_ptr 1
  .amdhsa_system_sgpr_workgroup_id_x 1
.end_amdhsa_kernel
```
